```python
import torch

def _softmax(x, axis=-1):
    return torch.softmax(x, dim=axis)
def _gelu(x):
    return torch.nn.functional.gelu(x, approximate="tanh")
def _silu(x):
    return torch.nn.functional.silu(x)
def _sigmoid(x):
    return torch.sigmoid(x)
def _layernorm(x, axis=-1, eps=1e-5):
    m = x.mean(dim=axis, keepdim=True)
    v = x.var(dim=axis, keepdim=True, unbiased=False)
    return (x - m) / torch.sqrt(v + eps)
def _scatter_add(tgt, idx, src, axis=0):
    return tgt.clone().index_add_(axis, idx, src)
def _segment_sum(src, seg, n):
    out = torch.zeros((n,) + src.shape[1:], dtype=src.dtype)
    return out.index_add_(0, seg, src)
def _pad(x, pw):
    flat = tuple(v for pair in reversed(pw) for v in pair)
    return torch.nn.functional.pad(x, flat)

kernel_name = 'gated_mix__sliding_local_dilated__sliding_local_dilated__prompt'

def setup_inputs():

    _w = (lambda a: (lambda t: t.to(torch.bfloat16) if t.is_floating_point() else t)(torch.as_tensor(a)))
    def _A_setup():
        B, S, D = 1, 2048, 640
        return {
            "x": _w((lambda *s: torch.randn(*s, dtype=torch.bfloat16) * 0.05)(B, S, D)),
            "wqkv": _w((lambda *s: torch.randn(*s, dtype=torch.bfloat16) * 0.8)(D, 3 * D)),
            "wo": _w((lambda *s: torch.randn(*s, dtype=torch.bfloat16) * 0.05)(D, D)),
        }
    _A_in = _A_setup()

    def _B_setup():
        B, S, D = 1, 2048, 640
        return {
            "x": _w((lambda *s: torch.randn(*s, dtype=torch.bfloat16) * 0.05)(B, S, D)),
            "wqkv": _w((lambda *s: torch.randn(*s, dtype=torch.bfloat16) * 0.8)(D, 3 * D)),
            "wo": _w((lambda *s: torch.randn(*s, dtype=torch.bfloat16) * 0.05)(D, D)),
        }
    _B_in = _B_setup()

    return {
        "A_x": _A_in["x"],
        "A_wqkv": _A_in["wqkv"],
        "A_wo": _A_in["wo"],
        "B_x": _B_in["x"],
        "B_wqkv": _B_in["wqkv"],
        "B_wo": _B_in["wo"],
        "gate_w": _w((lambda *s: torch.randn(*s, dtype=torch.bfloat16) * 0.05)(640) * 16.0),
    }

def reference(A_x, A_wqkv, A_wo, B_x, B_wqkv, B_wo, gate_w):
    def _A_ref(x, wqkv, wo):
        B, S, D = x.shape
        H = 32; Dh = D // H
        W, dil = 8, 2
        qkv = (lambda x, *d: x.permute(*d))((x @ wqkv).reshape(B, S, 3, H, Dh), 2, 0, 3, 1, 4)
        q, k, v = qkv[0], qkv[1], qkv[2]
        scale = Dh ** -0.5
        pos = torch.arange(S)
        off = torch.arange(W) * dil
        idx = pos[:, None] - off[None, :]
        mask = idx >= 0
        idx_c = torch.where(mask, idx, 0).reshape(-1)
        kg = k[:, :, idx_c, :].reshape(B, H, S, W, Dh)
        vg = v[:, :, idx_c, :].reshape(B, H, S, W, Dh)
        logits = torch.einsum("bhsd,bhswd->bhsw", q, kg) * scale
        logits = torch.where(mask[None, None, :, :], logits, -1e9)
        attn = _softmax(logits, axis=-1)
        o = torch.einsum("bhsw,bhswd->bhsd", attn, vg)
        return (lambda x, *d: x.permute(*d))(o, 0, 2, 1, 3).reshape(B, S, D) @ wo

    def _B_ref(x, wqkv, wo):
        B, S, D = x.shape
        H = 32; Dh = D // H
        W, dil = 8, 2
        qkv = (lambda x, *d: x.permute(*d))((x @ wqkv).reshape(B, S, 3, H, Dh), 2, 0, 3, 1, 4)
        q, k, v = qkv[0], qkv[1], qkv[2]
        scale = Dh ** -0.5
        pos = torch.arange(S)
        off = torch.arange(W) * dil
        idx = pos[:, None] - off[None, :]
        mask = idx >= 0
        idx_c = torch.where(mask, idx, 0).reshape(-1)
        kg = k[:, :, idx_c, :].reshape(B, H, S, W, Dh)
        vg = v[:, :, idx_c, :].reshape(B, H, S, W, Dh)
        logits = torch.einsum("bhsd,bhswd->bhsw", q, kg) * scale
        logits = torch.where(mask[None, None, :, :], logits, -1e9)
        attn = _softmax(logits, axis=-1)
        o = torch.einsum("bhsw,bhswd->bhsd", attn, vg)
        return (lambda x, *d: x.permute(*d))(o, 0, 2, 1, 3).reshape(B, S, D) @ wo

    x = A_x
    g = _sigmoid((x * gate_w).sum(-1, keepdims=True))
    a = _A_ref(x, A_wqkv, A_wo)
    b = _B_ref(x, B_wqkv, B_wo)
    return g * a + (1 - g) * b
```

```asm
; @launch grid=(256,1,1) block=(512,1,1) lds=163840
.amdgcn_target "amdgcn-amd-amdhsa--gfx950"
.text
.globl gated_mix__sliding_local_dilated__sliding_local_dilated__prompt_kernel
.p2align 8
.type gated_mix__sliding_local_dilated__sliding_local_dilated__prompt_kernel,@function
gated_mix__sliding_local_dilated__sliding_local_dilated__prompt_kernel:
    s_load_dwordx16 s[4:19], s[0:1], 0
    s_load_dwordx4 s[20:23], s[0:1], 64
    s_cmp_ge_u32 s2, 256
    s_cbranch_scc1 L_end
    s_getpc_b64 s[44:45]
L_pc:
    s_and_b32 s45, s45, 0xffff
    s_mov_b32 s46, L_end-L_pc
    s_mov_b32 s47, 0x20000
    v_lshlrev_b32 v2, 12, v0
    s_lshl_b32 s66, s2, 4
    s_and_b32 s66, s66, 3968
    v_lshrrev_b32 v3, 6, v0
    v_and_b32 v1, 63, v0
    buffer_load_dword v0, v2, s[44:47], s66 offen
    v_readfirstlane_b32 s60, v3
    s_and_b32 s61, s2, 1
    s_bfe_u32 s62, s2, 0x20001
    s_lshr_b32 s65, s2, 6
    s_bfe_u32 s63, s2, 0x30003
    s_lshl_b32 s66, s62, 2
    s_add_u32 s62, s66, s65
    s_lshl_b32 s64, s61, 3
    s_add_u32 s64, s64, s63
    s_mov_b32 s26, 2457600
    s_mov_b32 s27, 0x20000
    s_mov_b32 s30, 2621440
    s_mov_b32 s31, 0x20000
    s_mov_b32 s93, 0
    s_cmp_ge_u32 s60, 4
    s_cbranch_scc1 L_loader
    v_mul_u32_u24 v4, 13108, v1
    v_lshrrev_b32 v4, 16, v4
    v_mul_u32_u24 v4, 640, v4
    v_lshl_add_u32 v4, v1, 7, v4
    v_lshrrev_b32 v5, 1, v1
    v_mul_u32_u24 v5, 2304, v5
    v_lshl_add_u32 v5, v1, 7, v5
    s_lshr_b32 s66, s2, 3
    s_mul_i32 s67, s66, 15360
    s_bfe_u32 s68, s62, 0x10002
    s_mul_i32 s68, s68, 640
    s_add_u32 s67, s67, s68
    s_mul_i32 s66, s66, 81920
    s_mul_i32 s68, s61, 1280
    s_add_u32 s66, s66, s68
    s_waitcnt lgkmcnt(0)
    s_cmp_ge_u32 s62, 8
    s_cselect_b32 s24, s12, s6
    s_cselect_b32 s1, s13, s7
    s_and_b32 s25, s1, 0xffff
    s_mov_b32 s28, s4
    s_and_b32 s29, s5, 0xffff
    s_cmp_ge_u32 s60, 2
    s_cbranch_scc1 L_compute
    s_bitcmp1_b32 s60, 0
    s_cbranch_scc1 L_c0
    s_mov_b32 exec_hi, 0x0fffffff
    buffer_load_dword v0, v4, s[24:27], s67 offen
    s_mov_b64 exec, -1
    s_branch L_compute
L_c0:
    buffer_load_dword v0, v5, s[28:31], s66 offen
    s_branch L_compute
L_loader:
    s_sub_u32 s60, s60, 4
    s_and_b32 s66, s60, 1
    s_lshl_b32 s67, s66, 2
    v_lshrrev_b32 v4, 4, v1
    v_add_u32 v4, s67, v4
    v_and_b32 v5, 7, v1
    v_xor_b32 v4, v4, v5
    v_lshrrev_b32 v5, 3, v1
    v_mul_u32_u24 v3, 2560, v5
    v_lshl_add_u32 v3, v4, 4, v3
    v_mul_u32_u24 v2, 6554, v1
    v_lshrrev_b32 v2, 16, v2
    v_mul_u32_u24 v2, 1120, v2
    v_lshl_add_u32 v2, v1, 4, v2
    s_lshr_b32 s67, s60, 1
    s_mul_i32 s67, s67, 30720
    s_mul_i32 s66, s66, 7680
    s_add_u32 s95, s66, s67
    s_and_b32 s66, s62, 7
    s_mul_i32 s66, s66, 160
    s_add_u32 s95, s95, s66
    s_mul_i32 s66, s61, 1280
    s_mul_i32 s67, s60, 20480
    s_add_u32 s66, s66, s67
    s_mul_i32 s67, s63, 327680
    s_add_u32 s96, s66, s67
    s_sub_i32 s67, s67, 40960
    s_max_i32 s67, s67, 0
    s_add_u32 s97, s66, s67
    s_cmp_lg_u32 s60, 1
    s_cselect_b32 s97, 0x40000000, s97
    s_mul_i32 s99, s60, 960
    s_lshl_b32 s98, s60, 10
    s_add_u32 s98, s98, 30720
    s_mov_b32 s94, 0
    s_lshr_b32 s92, s60, 1
    s_cmp_eq_u32 s92, s61
    s_cselect_b32 s92, 8, 0
    s_lshl_b32 s56, s61, 1
    s_sub_u32 s56, 3, s56
    s_cmp_eq_u32 s60, s56
    s_cselect_b32 s56, 15, 7
    s_cmp_eq_u32 s60, 2
    s_cselect_b32 s56, 519, s56
    s_lshl_b32 s93, s60, 10
    s_cmp_eq_u32 s60, 1
    s_cselect_b32 s93, 0, s93
    s_sub_u32 s93, 16384, s93
    s_waitcnt lgkmcnt(0)
    s_cmp_eq_u32 s60, 2
    s_cselect_b32 s16, 8, 63
    s_cmp_ge_u32 s62, 8
    s_cselect_b32 s24, s12, s6
    s_cselect_b32 s1, s13, s7
    s_and_b32 s25, s1, 0xffff
    s_mov_b32 s28, s4
    s_and_b32 s29, s5, 0xffff
L_ld:
    s_add_u32 m0, s98, 0
    s_add_u32 s66, s96, 0
    buffer_load_dwordx4 v3, s[28:31], s66 offen lds
    s_add_u32 m0, s98, 4096
    s_add_u32 s66, s96, 81920
    buffer_load_dwordx4 v3, s[28:31], s66 offen lds
    s_add_u32 m0, s98, 8192
    s_add_u32 s66, s96, 163840
    buffer_load_dwordx4 v3, s[28:31], s66 offen lds
    s_add_u32 m0, s98, 12288
    s_add_u32 s66, s96, 245760
    buffer_load_dwordx4 v3, s[28:31], s66 offen lds
    s_add_u32 m0, s98, s93
    s_cmp_eq_u32 s94, s16
    s_cbranch_scc1 L_ldc
    buffer_load_dwordx4 v3, s[28:31], s97 offen lds
L_ldw:
    s_mov_b32 exec_hi, 0x0fffffff
    s_add_u32 m0, s99, 0
    s_add_u32 s66, s95, 0
    buffer_load_dwordx4 v2, s[24:27], s66 offen lds
    s_add_u32 m0, s99, 3840
    s_add_u32 s66, s95, 15360
    buffer_load_dwordx4 v2, s[24:27], s66 offen lds
    s_bitcmp1_b32 s56, s94
    s_cbranch_scc1 L_side
L_ldv:
    s_waitcnt vmcnt(7)
L_ldb:
    s_barrier
L_ld2:
    s_cmp_ge_u32 s94, s92
    s_cbranch_scc1 L_sxx
    s_load_dword s101, s[0:1], 0
    s_load_dword s101, s[0:1], 64
    s_load_dword s101, s[0:1], 128
    s_load_dword s101, s[0:1], 192
    s_load_dword s101, s[0:1], 256
    s_load_dword s101, s[0:1], 1280
    s_load_dword s101, s[0:1], 1344
    s_load_dword s101, s[0:1], 1408
    s_load_dword s101, s[0:1], 1472
    s_load_dword s101, s[0:1], 1536
    s_load_dword s101, s[0:1], 2560
    s_load_dword s101, s[0:1], 2624
    s_load_dword s101, s[0:1], 2688
    s_load_dword s101, s[0:1], 2752
    s_load_dword s101, s[0:1], 2816
    s_add_u32 s0, s0, 245760
    s_addc_u32 s1, s1, 0
L_ld3:
    s_add_u32 m0, s99, 7680
    s_add_u32 s66, s95, 61440
    buffer_load_dwordx4 v2, s[24:27], s66 offen lds
    s_add_u32 m0, s99, 11520
    s_add_u32 s66, s95, 76800
    buffer_load_dwordx4 v2, s[24:27], s66 offen lds
    s_add_u32 m0, s99, 15360
    s_add_u32 s66, s95, 122880
    buffer_load_dwordx4 v2, s[24:27], s66 offen lds
    s_add_u32 m0, s99, 19200
    s_add_u32 s66, s95, 138240
    buffer_load_dwordx4 v2, s[24:27], s66 offen lds
    s_add_u32 m0, s99, 23040
    s_add_u32 s66, s95, 184320
    buffer_load_dwordx4 v2, s[24:27], s66 offen lds
    s_add_u32 m0, s99, 26880
    s_add_u32 s66, s95, 199680
    buffer_load_dwordx4 v2, s[24:27], s66 offen lds
L_ld8:
    s_mov_b32 exec_hi, -1
    s_nop 0
    s_add_u32 s95, s95, 245760
    s_add_u32 s96, s96, 128
    s_add_u32 s97, s97, 128
    s_add_u32 s98, s98, 49152
    s_add_u32 s99, s99, 49152
    s_cmp_ge_u32 s99, 147456
    s_cselect_b32 s66, 147456, 0
    s_sub_u32 s98, s98, s66
    s_sub_u32 s99, s99, s66
    s_add_u32 s94, s94, 1
    s_cmp_lt_u32 s94, 10
    s_cbranch_scc1 L_ld
    s_branch L_ldtail
L_sxx:
    s_cmp_ge_u32 s94, s17
    s_cbranch_scc1 L_ld3
    s_load_dword s101, s[4:5], 0
    s_load_dword s101, s[4:5], 2560
    s_load_dword s101, s[4:5], 5120
    s_load_dword s101, s[4:5], 7680
    s_load_dword s101, s[4:5], 10240
    s_load_dword s101, s[4:5], 12800
    s_load_dword s101, s[4:5], 15360
    s_load_dword s101, s[4:5], 17920
    s_add_u32 s4, s4, 128
    s_addc_u32 s5, s5, 0
    s_branch L_ld3
L_ldc:
    s_mov_b32 s44, s20
    s_and_b32 s45, s21, 0xffff
    s_mov_b32 s46, 256
    s_mov_b32 s47, 0x20000
    v_lshlrev_b32 v5, 6, v1
    buffer_load_dword v13, v5, s[44:47], 0 offen sc1
    s_branch L_ldw
L_side:
    s_cmp_eq_u32 s94, 1
    s_cbranch_scc1 L_s1
    s_cmp_eq_u32 s94, 2
    s_cbranch_scc1 L_s2
    s_cmp_eq_u32 s94, 9
    s_cbranch_scc1 L_s9
    s_cmp_eq_u32 s94, 0
    s_cbranch_scc1 L_s0
    s_mov_b32 s3, 1
    s_lshl_b32 s66, s65, 6
    s_waitcnt vmcnt(7)
    s_barrier
    s_atomic_add s3, s[20:21], s66
    s_branch L_ld2
L_s0:
    s_lshr_b32 s66, s2, 3
    s_lshl_b32 s66, s66, 1
    s_lshr_b32 s67, s60, 1
    s_add_u32 s66, s66, s67
    s_mul_i32 s66, s66, 3840
    s_bfe_u32 s67, s62, 0x10002
    s_mul_i32 s67, s67, 640
    s_add_u32 s66, s66, s67
    s_and_b32 s67, s60, 1
    s_mul_i32 s67, s67, 320
    s_add_u32 s66, s66, s67
    s_add_u32 s66, s66, 491520
    s_add_u32 s0, s24, s66
    s_addc_u32 s1, s1, 0
    s_lshl_b32 s66, s63, 4
    s_add_u32 s66, s66, s62
    s_mul_i32 s66, s66, 20480
    s_mul_i32 s67, s61, 1280
    s_add_u32 s66, s66, s67
    s_and_b32 s67, s60, 1
    s_lshl_b32 s67, s67, 6
    s_add_u32 s66, s66, s67
    s_add_u32 s66, s66, 256
    s_add_u32 s4, s4, s66
    s_addc_u32 s5, s5, 0
    s_sub_u32 s17, 8, s92
    s_branch L_ld2
L_s1:
    s_mov_b32 exec_hi, -1
    v_lshrrev_b32 v10, 4, v1
    v_bfe_u32 v11, v1, 2, 2
    v_lshl_add_u32 v10, v10, 3, v11
    v_lshlrev_b32 v10, 7, v10
    v_and_b32 v11, 3, v1
    v_lshl_add_u32 v10, v11, 3, v10
    s_lshl_b32 s66, s60, 12
    s_add_u32 s66, s66, 147456
    v_add_u32 v10, s66, v10
    s_lshl_b32 s66, s60, 8
    s_add_u32 s66, s66, 149504
    v_lshl_add_u32 v11, v1, 2, s66
    s_waitcnt vmcnt(7)
    s_barrier
    s_mov_b32 exec_hi, -1
    ds_read_b32 v12, v11
    ds_read_b64_tr_b16 v[20:21], v10 offset:0
    ds_read_b64_tr_b16 v[22:23], v10 offset:512
    ds_read_b64_tr_b16 v[24:25], v10 offset:32
    ds_read_b64_tr_b16 v[26:27], v10 offset:544
    ds_read_b64_tr_b16 v[28:29], v10 offset:64
    ds_read_b64_tr_b16 v[30:31], v10 offset:576
    ds_read_b64_tr_b16 v[32:33], v10 offset:96
    ds_read_b64_tr_b16 v[34:35], v10 offset:608
    s_mov_b32 exec_hi, 0x0fffffff
    s_waitcnt lgkmcnt(0)
    s_branch L_ld2
L_s2:
    v_readlane_b32 s68, v12, 16
    v_readlane_b32 s69, v12, 17
    v_readlane_b32 s70, v12, 18
    v_readlane_b32 s71, v12, 19
    s_mov_b32 s40, s22
    s_and_b32 s41, s23, 0xffff
    s_mov_b32 s42, 268435456
    s_mov_b32 s43, 0x20000
    s_cmp_ge_u32 s68, 0x40000000
    s_cbranch_scc1 L_ldv
    s_mov_b32 exec_hi, -1
    v_lshlrev_b32 v11, 4, v1
    buffer_store_dwordx4 v[20:23], v11, s[40:43], s68 offen sc1
    buffer_store_dwordx4 v[24:27], v11, s[40:43], s69 offen sc1
    buffer_store_dwordx4 v[28:31], v11, s[40:43], s70 offen sc1
    buffer_store_dwordx4 v[32:35], v11, s[40:43], s71 offen sc1
    s_mov_b32 exec_hi, 0x0fffffff
    s_waitcnt vmcnt(11)
    s_branch L_ldb
L_s9:
    s_waitcnt vmcnt(13)
    v_readlane_b32 s32, v13, 0
    v_readlane_b32 s33, v13, 1
    v_readlane_b32 s34, v13, 2
    v_readlane_b32 s35, v13, 3
    s_mov_b32 s36, 0
L_s9l:
    s_waitcnt lgkmcnt(0)
    s_add_u32 s32, s32, s33
    s_add_u32 s34, s34, s35
    s_add_u32 s32, s32, s34
    s_cmp_ge_u32 s32, 256
    s_cbranch_scc1 L_ldv
    s_sleep 4
    s_load_dword s32, s[20:21], 0 glc
    s_load_dword s33, s[20:21], 64 glc
    s_load_dword s34, s[20:21], 128 glc
    s_load_dword s35, s[20:21], 192 glc
    s_add_u32 s36, s36, 1
    s_cmp_lt_u32 s36, 0x40000
    s_cbranch_scc1 L_s9l
    s_waitcnt lgkmcnt(0)
    s_branch L_ldv
L_ldtail:
    v_readlane_b32 s12, v12, 2
    v_readlane_b32 s100, v12, 11
    s_mov_b32 s40, s22
    s_and_b32 s41, s23, 0xffff
    s_mov_b32 s42, 268435456
    s_mov_b32 s43, 0x20000
    s_lshl_b32 s71, s12, 10
    s_add_u32 s71, s71, 61440
    v_lshl_add_u32 v14, v1, 4, s71
    v_add_u32 v15, 53248, v14
    v_lshlrev_b32 v2, 4, v1
    s_add_u32 m0, s71, 0
    s_add_u32 s66, s100, 0
    buffer_load_dwordx4 v2, s[40:43], s66 offen sc1 lds
    s_add_u32 m0, s71, 4096
    s_add_u32 s66, s100, 1024
    buffer_load_dwordx4 v2, s[40:43], s66 offen sc1 lds
    s_add_u32 m0, s71, 8192
    s_add_u32 s66, s100, 2048
    buffer_load_dwordx4 v2, s[40:43], s66 offen sc1 lds
    s_add_u32 m0, s71, 12288
    s_add_u32 s66, s100, 3072
    buffer_load_dwordx4 v2, s[40:43], s66 offen sc1 lds
    s_add_u32 m0, s71, 16384
    s_add_u32 s66, s100, 4096
    buffer_load_dwordx4 v2, s[40:43], s66 offen sc1 lds
    s_add_u32 m0, s71, 20480
    s_add_u32 s66, s100, 5120
    buffer_load_dwordx4 v2, s[40:43], s66 offen sc1 lds
    s_add_u32 m0, s71, 24576
    s_add_u32 s66, s100, 6144
    buffer_load_dwordx4 v2, s[40:43], s66 offen sc1 lds
    s_add_u32 m0, s71, 28672
    s_add_u32 s66, s100, 7168
    buffer_load_dwordx4 v2, s[40:43], s66 offen sc1 lds
    s_add_u32 m0, s71, 32768
    s_add_u32 s66, s100, 8192
    buffer_load_dwordx4 v2, s[40:43], s66 offen sc1 lds
    v_readlane_b32 s10, v12, 0
    v_readlane_b32 s11, v12, 1
    v_readlane_b32 s49, v12, 3
    v_readlane_b32 s50, v12, 4
    v_readlane_b32 s54, v12, 5
    v_readlane_b32 s55, v12, 6
    v_readlane_b32 s9, v12, 7
    v_readlane_b32 s57, v12, 8
    v_readlane_b32 s58, v12, 9
    v_readlane_b32 s59, v12, 10
    s_nop 0
    s_add_u32 s49, s49, 128
    s_add_u32 s50, s50, 2560
    s_add_u32 s51, s50, 5120
    s_add_u32 s52, s50, 10240
    s_add_u32 s53, s50, 15360
    s_add_u32 s60, s60, 4
    s_waitcnt vmcnt(9)
    s_barrier
    s_add_u32 m0, s71, 36864
    s_add_u32 s66, s100, 9216
    buffer_load_dwordx4 v2, s[40:43], s66 offen sc1 lds
    s_add_u32 m0, s71, 40960
    s_add_u32 s66, s100, 10240
    buffer_load_dwordx4 v2, s[40:43], s66 offen sc1 lds
    s_add_u32 m0, s71, 45056
    s_add_u32 s66, s100, 11264
    buffer_load_dwordx4 v2, s[40:43], s66 offen sc1 lds
    s_add_u32 m0, s71, 49152
    s_add_u32 s66, s100, 12288
    buffer_load_dwordx4 v2, s[40:43], s66 offen sc1 lds
    s_add_u32 m0, s71, 53248
    s_add_u32 s66, s100, 13312
    buffer_load_dwordx4 v2, s[40:43], s66 offen sc1 lds
    s_add_u32 m0, s71, 57344
    s_add_u32 s66, s100, 14336
    buffer_load_dwordx4 v2, s[40:43], s66 offen sc1 lds
    s_add_u32 m0, s71, 61440
    s_add_u32 s66, s100, 15360
    buffer_load_dwordx4 v2, s[40:43], s66 offen sc1 lds
    s_add_u32 m0, s71, 65536
    s_add_u32 s66, s100, 16384
    buffer_load_dwordx4 v2, s[40:43], s66 offen sc1 lds
    s_add_u32 m0, s71, 69632
    s_add_u32 s66, s100, 17408
    buffer_load_dwordx4 v2, s[40:43], s66 offen sc1 lds
    s_add_u32 m0, s71, 73728
    s_add_u32 s66, s100, 18432
    buffer_load_dwordx4 v2, s[40:43], s66 offen sc1 lds
    s_add_u32 m0, s71, 77824
    s_add_u32 s66, s100, 19456
    buffer_load_dwordx4 v2, s[40:43], s66 offen sc1 lds
    s_add_u32 m0, s71, 81920
    s_add_u32 s66, s100, 20480
    buffer_load_dwordx4 v2, s[40:43], s66 offen sc1 lds
    s_waitcnt vmcnt(6)
    s_barrier
    ds_read_b128 a[44:47], v14 offset:0
    ds_read_b128 a[48:51], v14 offset:4096
    ds_read_b128 a[52:55], v14 offset:8192
    s_add_u32 m0, s71, 86016
    s_add_u32 s66, s100, 21504
    buffer_load_dwordx4 v2, s[40:43], s66 offen sc1 lds
    ds_read_b128 a[56:59], v14 offset:12288
    ds_read_b128 a[76:79], v14 offset:16384
    ds_read_b128 a[80:83], v14 offset:20480
    s_add_u32 m0, s71, 90112
    s_add_u32 s66, s100, 22528
    buffer_load_dwordx4 v2, s[40:43], s66 offen sc1 lds
    ds_read_b128 a[84:87], v14 offset:24576
    ds_read_b128 a[96:99], v14 offset:28672
    ds_read_b128 a[100:103], v14 offset:32768
    s_add_u32 m0, s71, 94208
    s_add_u32 s66, s100, 23552
    buffer_load_dwordx4 v2, s[40:43], s66 offen sc1 lds
    ds_read_b128 a[20:23], v14 offset:36864
    ds_read_b128 a[24:27], v14 offset:40960
    ds_read_b128 a[28:31], v14 offset:45056
    s_add_u32 m0, s71, 98304
    s_add_u32 s66, s100, 24576
    buffer_load_dwordx4 v2, s[40:43], s66 offen sc1 lds
    ds_read_b128 a[32:35], v14 offset:49152
    ds_read_b128 a[36:39], v15 offset:0
    ds_read_b128 a[0:3], v15 offset:4096
    s_sub_u32 m0, s71, 40960
    s_add_u32 s66, s100, 102400
    buffer_load_dwordx4 v2, s[40:43], s66 offen sc1 lds
    s_sub_u32 m0, s71, 36864
    s_add_u32 s66, s100, 103424
    buffer_load_dwordx4 v2, s[40:43], s66 offen sc1 lds
    s_sub_u32 m0, s71, 32768
    s_add_u32 s66, s100, 104448
    buffer_load_dwordx4 v2, s[40:43], s66 offen sc1 lds
    s_sub_u32 m0, s71, 28672
    s_add_u32 s66, s100, 105472
    buffer_load_dwordx4 v2, s[40:43], s66 offen sc1 lds
    s_sub_u32 m0, s71, 24576
    s_add_u32 s66, s100, 106496
    buffer_load_dwordx4 v2, s[40:43], s66 offen sc1 lds
    s_sub_u32 m0, s71, 20480
    s_add_u32 s66, s100, 107520
    buffer_load_dwordx4 v2, s[40:43], s66 offen sc1 lds
    s_sub_u32 m0, s71, 16384
    s_add_u32 s66, s100, 108544
    buffer_load_dwordx4 v2, s[40:43], s66 offen sc1 lds
    s_sub_u32 m0, s71, 12288
    s_add_u32 s66, s100, 109568
    buffer_load_dwordx4 v2, s[40:43], s66 offen sc1 lds
    s_sub_u32 m0, s71, 8192
    s_add_u32 s66, s100, 110592
    buffer_load_dwordx4 v2, s[40:43], s66 offen sc1 lds
    s_sub_u32 m0, s71, 4096
    s_add_u32 s66, s100, 111616
    buffer_load_dwordx4 v2, s[40:43], s66 offen sc1 lds
    s_waitcnt lgkmcnt(0)
    s_barrier
    s_add_u32 m0, s71, 0
    s_add_u32 s66, s100, 112640
    buffer_load_dwordx4 v2, s[40:43], s66 offen sc1 lds
    s_add_u32 m0, s71, 4096
    s_add_u32 s66, s100, 113664
    buffer_load_dwordx4 v2, s[40:43], s66 offen sc1 lds
    s_add_u32 m0, s71, 8192
    s_add_u32 s66, s100, 114688
    buffer_load_dwordx4 v2, s[40:43], s66 offen sc1 lds
    s_add_u32 m0, s71, 12288
    s_add_u32 s66, s100, 115712
    buffer_load_dwordx4 v2, s[40:43], s66 offen sc1 lds
    s_add_u32 m0, s71, 16384
    s_add_u32 s66, s100, 116736
    buffer_load_dwordx4 v2, s[40:43], s66 offen sc1 lds
    s_add_u32 m0, s71, 20480
    s_add_u32 s66, s100, 117760
    buffer_load_dwordx4 v2, s[40:43], s66 offen sc1 lds
    s_add_u32 m0, s71, 24576
    s_add_u32 s66, s100, 118784
    buffer_load_dwordx4 v2, s[40:43], s66 offen sc1 lds
    s_add_u32 m0, s71, 28672
    s_add_u32 s66, s100, 119808
    buffer_load_dwordx4 v2, s[40:43], s66 offen sc1 lds
    s_add_u32 m0, s71, 32768
    s_add_u32 s66, s100, 120832
    buffer_load_dwordx4 v2, s[40:43], s66 offen sc1 lds
    s_add_u32 m0, s71, 36864
    s_add_u32 s66, s100, 121856
    buffer_load_dwordx4 v2, s[40:43], s66 offen sc1 lds
    s_add_u32 m0, s71, 40960
    s_add_u32 s66, s100, 122880
    buffer_load_dwordx4 v2, s[40:43], s66 offen sc1 lds
    s_add_u32 m0, s71, 45056
    s_add_u32 s66, s100, 123904
    buffer_load_dwordx4 v2, s[40:43], s66 offen sc1 lds
    s_add_u32 m0, s71, 49152
    s_add_u32 s66, s100, 124928
    buffer_load_dwordx4 v2, s[40:43], s66 offen sc1 lds
    s_add_u32 m0, s71, 53248
    s_add_u32 s66, s100, 125952
    buffer_load_dwordx4 v2, s[40:43], s66 offen sc1 lds
    s_add_u32 m0, s71, 57344
    s_add_u32 s66, s100, 126976
    buffer_load_dwordx4 v2, s[40:43], s66 offen sc1 lds
    s_waitcnt vmcnt(25)
    s_barrier
    ds_read_b128 a[4:7], v15 offset:8192
    ds_read_b128 a[8:11], v15 offset:12288
    ds_read_b128 a[12:15], v15 offset:16384
    ds_read_b128 a[16:19], v15 offset:20480
    ds_read_b128 a[40:43], v15 offset:24576
    ds_read_b128 a[60:63], v15 offset:28672
    ds_read_b128 a[64:67], v15 offset:32768
    ds_read_b128 a[68:71], v15 offset:36864
    ds_read_b128 a[72:75], v15 offset:40960
    ds_read_b128 a[88:91], v15 offset:45056
    v_lshlrev_b32 v2, 4, v1
    v_add_u32 v3, 81920, v2
    v_subrev_u32 v111, 40960, v14
    v_and_b32 v4, 0x1f0, v2
    v_lshrrev_b32 v5, 5, v1
    v_lshl_add_u32 v4, v5, 3, v4
    v_add_u32 v5, 81920, v4
    v_bfe_u32 v8, v1, 3, 2
    v_bfe_u32 v9, v1, 1, 2
    v_lshl_add_u32 v8, v9, 2, v8
    v_mul_u32_u24 v8, 2560, v8
    v_and_b32 v9, 1, v1
    v_lshl_add_u32 v8, v9, 4, v8
    v_lshrrev_b32 v9, 5, v1
    v_mad_u32_u24 v12, v9, s9, v8
    v_mad_u32_u24 v13, v9, s59, v8
    v_lshl_add_u32 v10, v1, 5, s54
    v_lshl_add_u32 v11, v1, 5, s57
    s_mov_b32 s44, s18
    s_and_b32 s45, s19, 0xffff
    s_mov_b32 s46, 2621440
    s_mov_b32 s47, 0x20000
    s_waitcnt vmcnt(0) lgkmcnt(0)
    s_load_dwordx16 s[24:39], s[22:23], s49 glc
    s_barrier
    s_mov_b32 s67, 0
    s_branch L_pw
    s_branch L_ph2
L_compute:
    s_mov_b32 s36, s2
    s_lshl_b32 s36, s36, 1
    s_and_b32 s66, s60, 1
    s_add_u32 s36, s36, s66
    s_cmp_lt_u32 s60, 2
    s_cselect_b32 s36, 0x3ff, s36
    s_lshl_b32 s3, s60, 12
    s_add_u32 s3, s3, 147456
    s_mul_i32 s39, s36, 6554
    s_lshr_b32 s39, s39, 16
    s_mul_i32 s66, s39, 10
    s_sub_u32 s37, s36, s66
    s_mul_i32 s38, s39, 52
    s_lshr_b32 s38, s38, 8
    s_mul_i32 s66, s38, 5
    s_sub_u32 s39, s39, s66
    s_cmp_ge_u32 s60, 2
    s_cbranch_scc1 L_cr
    s_mov_b32 s44, s16
    s_and_b32 s45, s17, 0xffff
    s_mov_b32 s46, 1280
    s_mov_b32 s47, 0x20000
    s_lshl_b32 s66, s60, 10
    s_add_u32 m0, s66, 147456
    v_lshlrev_b32 v4, 4, v1
    buffer_load_dwordx4 v4, s[44:47], s66 offen lds
L_cr:
    s_cmp_ge_u32 s36, 400
    s_cbranch_scc1 L_cs
    s_mul_i32 s66, s39, 40
    s_cmp_eq_u32 s39, 4
    s_cselect_b32 s66, 16, s66
    s_cselect_b32 s67, 76, 16
    s_cselect_b32 s68, 20, 4
    s_mul_i32 s68, s68, 1280
    s_and_b32 s69, s38, 3
    s_mul_i32 s69, s69, 160
    s_add_u32 s66, s66, s69
    s_mul_i32 s66, s66, 1280
    s_lshl_b32 s69, s37, 7
    s_add_u32 s66, s66, s69
    v_lshrrev_b32 v4, 3, v1
    v_lshrrev_b32 v5, 5, v1
    v_mul_u32_u24 v5, s67, v5
    v_add_u32 v4, v4, v5
    v_mul_u32_u24 v4, 1280, v4
    v_and_b32 v5, 7, v1
    v_lshl_add_u32 v4, v5, 4, v4
    s_cmp_ge_u32 s38, 4
    s_cselect_b32 s44, s14, s8
    s_cselect_b32 s45, s15, s9
    s_and_b32 s45, s45, 0xffff
    s_mov_b32 s46, 819200
    s_mov_b32 s47, 0x20000
    s_add_u32 m0, s3, 0
    s_nop 0
    buffer_load_dwordx4 v4, s[44:47], s66 offen nt lds
    s_add_u32 m0, s3, 1024
    s_add_u32 s66, s66, s68
    buffer_load_dwordx4 v4, s[44:47], s66 offen nt lds
    s_add_u32 m0, s3, 2048
    s_add_u32 s66, s66, s68
    buffer_load_dwordx4 v4, s[44:47], s66 offen nt lds
    s_add_u32 m0, s3, 3072
    s_add_u32 s66, s66, s68
    buffer_load_dwordx4 v4, s[44:47], s66 offen nt lds
L_cs:
    s_mov_b32 s40, s22
    s_and_b32 s41, s23, 0xffff
    s_mov_b32 s42, 268435456
    s_mov_b32 s43, 0x20000
    s_and_b32 s66, s38, 1
    s_lshl_b32 s66, s66, 2
    s_lshr_b32 s67, s38, 1
    s_add_u32 s66, s66, s67
    s_mul_i32 s66, s66, 25600
    s_mul_i32 s67, s39, 5120
    s_add_u32 s66, s66, s67
    s_add_u32 s66, s66, 6815744
    s_cmp_ge_u32 s36, 400
    s_cselect_b32 s66, 0x40000000, s66
    s_lshl_b32 s67, s37, 2
    s_add_u32 s67, s67, 0
    s_mul_i32 s13, s67, 52
    s_lshr_b32 s13, s13, 8
    s_mul_i32 s13, s13, 199680
    s_lshl_b32 s67, s67, 10
    s_add_u32 s67, s67, s13
    s_add_u32 s67, s67, s66
    v_writelane_b32 v14, s67, 16
    s_lshl_b32 s67, s37, 2
    s_add_u32 s67, s67, 1
    s_mul_i32 s13, s67, 52
    s_lshr_b32 s13, s13, 8
    s_mul_i32 s13, s13, 199680
    s_lshl_b32 s67, s67, 10
    s_add_u32 s67, s67, s13
    s_add_u32 s67, s67, s66
    v_writelane_b32 v14, s67, 17
    s_lshl_b32 s67, s37, 2
    s_add_u32 s67, s67, 2
    s_mul_i32 s13, s67, 52
    s_lshr_b32 s13, s13, 8
    s_mul_i32 s13, s13, 199680
    s_lshl_b32 s67, s67, 10
    s_add_u32 s67, s67, s13
    s_add_u32 s67, s67, s66
    v_writelane_b32 v14, s67, 18
    s_lshl_b32 s67, s37, 2
    s_add_u32 s67, s67, 3
    s_mul_i32 s13, s67, 52
    s_lshr_b32 s13, s13, 8
    s_mul_i32 s13, s13, 199680
    s_lshl_b32 s67, s67, 10
    s_add_u32 s67, s67, s13
    s_add_u32 s67, s67, s66
    v_writelane_b32 v14, s67, 19
    s_and_b32 s48, s2, 7
    s_lshl_b32 s48, s48, 2
    s_add_u32 s48, s48, s65
    s_lshl_b32 s66, s64, 7
    s_add_u32 s66, s66, 6356992
    s_load_dword s10, s[22:23], s66
    s_lshr_b32 s67, s48, 1
    s_lshl_b32 s67, s67, 7
    s_add_u32 s67, s67, 6356992
    s_load_dword s11, s[22:23], s67
    s_lshl_b32 s56, s64, 1
    s_lshr_b32 s66, s60, 1
    s_add_u32 s56, s56, s66
    s_lshl_b32 s56, s56, 2
    s_lshr_b32 s66, s62, 2
    s_add_u32 s56, s56, s66
    s_lshl_b32 s56, s56, 8
    s_and_b32 s66, s60, 1
    s_lshl_b32 s66, s66, 5
    s_add_u32 s56, s56, s66
    s_lshl_b32 s66, s65, 3
    s_add_u32 s56, s56, s66
    s_add_u32 s56, s56, 6389760
    s_xor_b32 s12, s60, s63
    s_and_b32 s12, s12, 3
    s_lshl_b32 s50, s48, 3
    s_add_u32 s50, s50, s12
    s_mul_i32 s50, s50, 20480
    s_add_u32 s51, s50, 5120
    s_add_u32 s52, s50, 10240
    s_add_u32 s53, s50, 15360
    s_lshl_b32 s49, s48, 2
    s_add_u32 s49, s49, s12
    s_lshl_b32 s49, s49, 8
    s_add_u32 s49, s49, 6389760
    s_and_b32 s13, s63, 0
    s_lshl_b32 s13, s13, 15
    s_add_u32 s49, s49, s13
    s_load_dword s17, s[22:23], s49 glc
    s_add_u32 s13, s49, 128
    s_load_dword s17, s[22:23], s13 glc
    s_and_b32 s13, s48, 15
    s_mul_i32 s13, s13, 163840
    s_lshr_b32 s14, s48, 4
    s_mul_i32 s14, s14, 1280
    s_add_u32 s13, s13, s14
    s_mul_i32 s14, s63, 160
    s_add_u32 s13, s13, s14
    s_mov_b32 s14, s60
    s_lshl_b32 s54, s14, 11
    s_cmp_ge_u32 s14, 5
    s_cselect_b32 s15, 133120, 0
    s_cselect_b32 s16, 0, 40960
    s_add_u32 s54, s54, 122880
    s_sub_u32 s54, s54, s15
    s_add_u32 s55, s13, s16
    s_cmp_ge_u32 s14, 5
    s_cselect_b32 s15, 5, 0
    s_sub_u32 s14, s14, s15
    s_lshl_b32 s15, s14, 6
    s_add_u32 s55, s55, s15
    s_cmp_ge_u32 s14, 3
    s_cselect_b32 s15, 81760, 0
    s_add_u32 s55, s55, s15
    s_cmp_eq_u32 s14, 2
    s_cselect_b32 s9, 81792, 32
    s_mul_i32 s14, s60, 5
    s_add_u32 s14, s14, 4
    s_lshl_b32 s5, s14, 11
    s_cmp_ge_u32 s14, 5
    s_cselect_b32 s15, 133120, 0
    s_cselect_b32 s16, 0, 40960
    s_add_u32 s5, s5, 122880
    s_sub_u32 s5, s5, s15
    s_add_u32 s6, s13, s16
    s_cmp_ge_u32 s14, 5
    s_cselect_b32 s15, 5, 0
    s_sub_u32 s14, s14, s15
    s_lshl_b32 s15, s14, 6
    s_add_u32 s6, s6, s15
    s_cmp_ge_u32 s14, 3
    s_cselect_b32 s15, 81760, 0
    s_add_u32 s6, s6, s15
    s_cmp_eq_u32 s14, 2
    s_cselect_b32 s7, 81792, 32
    s_add_u32 s14, s60, 5
    s_lshl_b32 s57, s14, 11
    s_cmp_ge_u32 s14, 5
    s_cselect_b32 s15, 133120, 0
    s_cselect_b32 s16, 0, 40960
    s_add_u32 s57, s57, 122880
    s_sub_u32 s57, s57, s15
    s_add_u32 s58, s13, s16
    s_cmp_ge_u32 s14, 5
    s_cselect_b32 s15, 5, 0
    s_sub_u32 s14, s14, s15
    s_lshl_b32 s15, s14, 6
    s_add_u32 s58, s58, s15
    s_cmp_ge_u32 s14, 3
    s_cselect_b32 s15, 81760, 0
    s_add_u32 s58, s58, s15
    s_cmp_eq_u32 s14, 2
    s_cselect_b32 s59, 81792, 32
    s_mul_i32 s100, s63, 204800
    s_mul_i32 s13, s12, 25600
    s_add_u32 s100, s100, s13
    s_add_u32 s100, s100, 6815744
    v_writelane_b32 v14, s12, 2
    v_writelane_b32 v14, s49, 3
    v_writelane_b32 v14, s50, 4
    v_writelane_b32 v14, s54, 5
    v_writelane_b32 v14, s55, 6
    v_writelane_b32 v14, s9, 7
    v_writelane_b32 v14, s5, 8
    v_writelane_b32 v14, s6, 9
    v_writelane_b32 v14, s7, 10
    v_writelane_b32 v14, s100, 11
    s_lshl_b32 s4, s93, 7
    v_lshrrev_b32 v10, 4, v1
    v_bfe_u32 v11, v1, 2, 2
    v_and_b32 v12, 3, v1
    v_lshrrev_b32 v13, 1, v10
    v_lshlrev_b32 v13, 4, v13
    v_and_b32 v15, 1, v10
    v_lshl_add_u32 v13, v15, 2, v13
    v_add_u32 v13, v13, v11
    v_mul_u32_u24 v13, 480, v13
    v_lshl_add_u32 v2, v12, 3, v13
    v_mul_u32_u24 v15, 40, v12
    v_add3_u32 v3, v13, v15, 32
    v_and_b32 v11, 15, v1
    v_lshrrev_b32 v12, 1, v11
    v_xor_b32 v12, v12, v10
    v_lshlrev_b32 v12, 4, v12
    v_lshl_add_u32 v4, v11, 7, v12
    v_xor_b32 v5, 64, v4
    v_pk_mov_b32 v[10:11], 0, 0
    v_pk_mov_b32 v[12:13], 0, 0
    v_pk_mov_b32 v[148:149], 0, 0
    v_pk_mov_b32 v[150:151], 0, 0
    v_pk_mov_b32 v[16:17], 0, 0
    v_pk_mov_b32 v[18:19], 0, 0
    v_pk_mov_b32 v[20:21], 0, 0
    v_pk_mov_b32 v[22:23], 0, 0
    v_pk_mov_b32 v[24:25], 0, 0
    v_pk_mov_b32 v[26:27], 0, 0
    v_pk_mov_b32 v[28:29], 0, 0
    v_pk_mov_b32 v[30:31], 0, 0
    v_pk_mov_b32 v[32:33], 0, 0
    v_pk_mov_b32 v[34:35], 0, 0
    v_pk_mov_b32 v[36:37], 0, 0
    v_pk_mov_b32 v[38:39], 0, 0
    v_pk_mov_b32 v[40:41], 0, 0
    v_pk_mov_b32 v[42:43], 0, 0
    v_pk_mov_b32 v[44:45], 0, 0
    v_pk_mov_b32 v[46:47], 0, 0
    v_pk_mov_b32 v[48:49], 0, 0
    v_pk_mov_b32 v[50:51], 0, 0
    v_pk_mov_b32 v[52:53], 0, 0
    v_pk_mov_b32 v[54:55], 0, 0
    v_pk_mov_b32 v[56:57], 0, 0
    v_pk_mov_b32 v[58:59], 0, 0
    v_pk_mov_b32 v[60:61], 0, 0
    v_pk_mov_b32 v[62:63], 0, 0
    v_pk_mov_b32 v[64:65], 0, 0
    v_pk_mov_b32 v[66:67], 0, 0
    v_pk_mov_b32 v[68:69], 0, 0
    v_pk_mov_b32 v[70:71], 0, 0
    v_pk_mov_b32 v[72:73], 0, 0
    v_pk_mov_b32 v[74:75], 0, 0
    v_pk_mov_b32 v[76:77], 0, 0
    v_pk_mov_b32 v[78:79], 0, 0
    v_pk_mov_b32 v[80:81], 0, 0
    v_pk_mov_b32 v[82:83], 0, 0
    v_pk_mov_b32 v[84:85], 0, 0
    v_pk_mov_b32 v[86:87], 0, 0
    v_pk_mov_b32 v[88:89], 0, 0
    v_pk_mov_b32 v[90:91], 0, 0
    v_pk_mov_b32 v[92:93], 0, 0
    v_pk_mov_b32 v[94:95], 0, 0
    v_pk_mov_b32 v[96:97], 0, 0
    v_pk_mov_b32 v[98:99], 0, 0
    v_pk_mov_b32 v[100:101], 0, 0
    v_pk_mov_b32 v[102:103], 0, 0
    v_pk_mov_b32 v[104:105], 0, 0
    v_pk_mov_b32 v[106:107], 0, 0
    v_pk_mov_b32 v[108:109], 0, 0
    v_pk_mov_b32 v[110:111], 0, 0
    v_pk_mov_b32 v[112:113], 0, 0
    v_pk_mov_b32 v[114:115], 0, 0
    v_pk_mov_b32 v[116:117], 0, 0
    v_pk_mov_b32 v[118:119], 0, 0
    v_pk_mov_b32 v[120:121], 0, 0
    v_pk_mov_b32 v[122:123], 0, 0
    v_pk_mov_b32 v[124:125], 0, 0
    v_pk_mov_b32 v[126:127], 0, 0
    v_pk_mov_b32 v[128:129], 0, 0
    v_pk_mov_b32 v[130:131], 0, 0
    v_pk_mov_b32 v[132:133], 0, 0
    v_pk_mov_b32 v[134:135], 0, 0
    v_pk_mov_b32 v[136:137], 0, 0
    v_pk_mov_b32 v[138:139], 0, 0
    v_pk_mov_b32 v[140:141], 0, 0
    v_pk_mov_b32 v[142:143], 0, 0
    v_pk_mov_b32 v[144:145], 0, 0
    v_pk_mov_b32 v[146:147], 0, 0
    s_or_b32 s66, s63, s60
    s_cmp_eq_u32 s66, 0
    s_mov_b32 s92, 0x0
    s_mov_b32 s93, 0xf0000
    s_cselect_b64 s[24:25], 0, s[92:93]
    s_mov_b32 s94, 0x0
    s_mov_b32 s95, 0x1f0001
    s_cselect_b64 s[26:27], 0, s[94:95]
    s_mov_b32 s96, 0x0
    s_mov_b32 s97, 0x3f0003
    s_cselect_b64 s[28:29], 0, s[96:97]
    s_mov_b32 s98, 0x0
    s_mov_b32 s99, 0x7f0007
    s_cselect_b64 s[30:31], 0, s[98:99]
    s_mov_b32 s32, 0xffff
    s_mov_b32 s33, 0x0
    s_mov_b32 s34, 0xffff0000
    s_mov_b32 s35, 0x0
    s_mov_b32 s36, 0x0
    s_mov_b32 s37, 0xffff
    s_mov_b32 s38, 0x0
    s_mov_b32 s39, 0xffff0000
    s_mov_b32 s0, 0xff000ff
    s_mov_b32 s1, 0xf000ff00
    s_mov_b32 s6, 0x1fe001fe
    s_mov_b32 s7, 0xe000fe00
    s_mov_b32 s44, 0x3fc003fc
    s_mov_b32 s45, 0xc000fc00
    s_mov_b32 s46, 0x7f8007f8
    s_mov_b32 s47, 0x8000f800
    s_mov_b32 s68, 0x3ea52b5c
    s_mov_b32 s69, 0x3ea52b5c
    s_mov_b32 s101, 0xbea52b5c
    s_lshl_b32 s100, s64, 2
    s_add_u32 s100, s100, s60
    s_lshl_b32 s100, s100, 4
    s_add_u32 s100, s100, s62
    s_mul_i32 s100, s100, 5120
    s_add_u32 s67, s100, 2560
    s_mul_i32 s66, s60, 5120
    s_lshl_b32 s13, s60, 9
    s_cmp_lt_u32 s60, 2
    s_cselect_b32 s14, s13, 0x40000
    s_cmp_lt_u32 s60, 3
    s_cselect_b32 s15, s66, 0x40000
    s_lshl_b32 s16, s4, 31
    s_sub_u32 s16, 128, s16
    s_mov_b32 s70, 0
    s_mov_b32 s71, 0
    s_add_u32 s5, s4, 147456
    s_lshl_b32 s3, s60, 8
    s_add_u32 s3, s3, 149504
    v_lshl_add_u32 v7, v1, 2, s3
    s_waitcnt lgkmcnt(0)
    s_mul_i32 s10, s10, 0x9e3779b1
    s_add_u32 s10, s10, 0x7f4a7c15
    s_mul_i32 s11, s11, 0x9e3779b1
    s_add_u32 s11, s11, 0x7f4a7c15
    v_writelane_b32 v14, s10, 0
    v_writelane_b32 v14, s11, 1
    ds_write_b32 v7, v14
    s_waitcnt vmcnt(0) lgkmcnt(0)
    v_mov_b32 v6, v2
    v_mov_b32 v7, v3
    v_mov_b32 v8, v4
    v_mov_b32 v9, v5
    s_lshl_b32 s71, s12, 10
    s_add_u32 s71, s71, 61440
    v_lshl_add_u32 v14, v1, 4, s71
    v_add_u32 v15, 53248, v14
    s_mov_b32 s71, 0
    v_and_b32 v0, 48, v1
    v_add_u32 v0, s5, v0
    s_cmp_eq_u32 s60, 1
    s_cbranch_scc1 L_g1
    s_cmp_eq_u32 s60, 2
    s_cbranch_scc1 L_g2
    s_cmp_eq_u32 s60, 3
    s_cbranch_scc1 L_g3
L_g0:
    s_barrier
    ds_read_b128 a[76:79], v8 offset:30720
    ds_read_b128 a[80:83], v8 offset:32768
    ds_read_b128 a[84:87], v8 offset:47104
    ds_read_b128 a[100:103], v0
    ds_read_b64_tr_b16 a[0:1], v6 offset:0
    ds_read_b64_tr_b16 a[2:3], v6 offset:3840
    ds_read_b64_tr_b16 a[4:5], v6 offset:40
    ds_read_b64_tr_b16 a[6:7], v6 offset:3880
    ds_read_b64_tr_b16 a[8:9], v6 offset:80
    ds_read_b64_tr_b16 a[10:11], v6 offset:3920
    ds_read_b64_tr_b16 a[12:13], v6 offset:120
    ds_read_b64_tr_b16 a[14:15], v6 offset:3960
    ds_read_b64_tr_b16 a[16:17], v7 offset:0
    ds_read_b64_tr_b16 a[18:19], v7 offset:3840
    ds_read_b64_tr_b16 a[20:21], v6 offset:160
    ds_read_b64_tr_b16 a[22:23], v6 offset:4000
    ds_read_b64_tr_b16 a[24:25], v6 offset:200
    ds_read_b64_tr_b16 a[26:27], v6 offset:4040
    ds_read_b64_tr_b16 a[28:29], v6 offset:240
    ds_read_b64_tr_b16 a[30:31], v6 offset:4080
    ds_read_b64_tr_b16 a[32:33], v6 offset:280
    ds_read_b64_tr_b16 a[34:35], v6 offset:4120
    ds_read_b64_tr_b16 a[36:37], v7 offset:160
    ds_read_b64_tr_b16 a[38:39], v7 offset:4000
    ds_read_b64_tr_b16 a[40:41], v6 offset:320
    ds_read_b64_tr_b16 a[42:43], v6 offset:4160
    ds_read_b64_tr_b16 a[44:45], v6 offset:360
    ds_read_b64_tr_b16 a[46:47], v6 offset:4200
    ds_read_b64_tr_b16 a[48:49], v6 offset:400
    ds_read_b64_tr_b16 a[50:51], v6 offset:4240
    ds_read_b64_tr_b16 a[52:53], v6 offset:440
    ds_read_b64_tr_b16 a[54:55], v6 offset:4280
    ds_read_b64_tr_b16 a[56:57], v7 offset:320
    ds_read_b64_tr_b16 a[58:59], v7 offset:4160
    s_waitcnt lgkmcnt(0)
    .p2align 6
L_gl0:
    v_mfma_f32_16x16x32_bf16 v[10:13], a[100:103], a[76:79], v[10:13]
    ds_read_b128 a[88:91], v9 offset:30720
    v_mfma_f32_16x16x32_bf16 v[148:151], a[100:103], a[80:83], v[148:151]
    ds_read_b128 a[92:95], v9 offset:32768
    v_mfma_f32_16x16x32_bf16 v[16:19], a[0:3], a[76:79], v[16:19]
    ds_read_b128 a[96:99], v9 offset:47104
    v_mfma_f32_16x16x32_bf16 v[76:79], a[0:3], a[80:83], v[76:79]
    v_mfma_f32_16x16x32_bf16 v[20:23], a[4:7], a[76:79], v[20:23]
    ds_read_b64_tr_b16 a[0:1], v6 offset:15360
    ds_read_b64_tr_b16 a[60:61], v6 offset:15720
    v_mfma_f32_16x16x32_bf16 v[80:83], a[4:7], a[80:83], v[80:83]
    ds_read_b64_tr_b16 a[2:3], v6 offset:19200
    v_mfma_f32_16x16x32_bf16 v[24:27], a[8:11], a[76:79], v[24:27]
    ds_read_b64_tr_b16 a[4:5], v6 offset:15400
    ds_read_b64_tr_b16 a[62:63], v6 offset:19560
    v_mfma_f32_16x16x32_bf16 v[84:87], a[8:11], a[80:83], v[84:87]
    ds_read_b64_tr_b16 a[6:7], v6 offset:19240
    v_mfma_f32_16x16x32_bf16 v[28:31], a[12:15], a[76:79], v[28:31]
    ds_read_b64_tr_b16 a[8:9], v6 offset:15440
    ds_read_b64_tr_b16 a[64:65], v6 offset:15760
    v_mfma_f32_16x16x32_bf16 v[88:91], a[12:15], a[80:83], v[88:91]
    ds_read_b64_tr_b16 a[10:11], v6 offset:19280
    v_mfma_f32_16x16x32_bf16 v[32:35], a[16:19], a[76:79], v[32:35]
    ds_read_b64_tr_b16 a[12:13], v6 offset:15480
    ds_read_b64_tr_b16 a[66:67], v6 offset:19600
    v_mfma_f32_16x16x32_bf16 v[92:95], a[16:19], a[80:83], v[92:95]
    ds_read_b64_tr_b16 a[14:15], v6 offset:19320
    v_mfma_f32_16x16x32_bf16 v[36:39], a[20:23], a[76:79], v[36:39]
    ds_read_b64_tr_b16 a[16:17], v7 offset:15360
    ds_read_b64_tr_b16 a[68:69], v6 offset:15800
    v_mfma_f32_16x16x32_bf16 v[96:99], a[20:23], a[80:83], v[96:99]
    ds_read_b64_tr_b16 a[18:19], v7 offset:19200
    v_mfma_f32_16x16x32_bf16 v[136:139], a[20:23], a[84:87], v[136:139]
    v_mfma_f32_16x16x32_bf16 v[40:43], a[24:27], a[76:79], v[40:43]
    ds_read_b64_tr_b16 a[20:21], v6 offset:15520
    ds_read_b64_tr_b16 a[70:71], v6 offset:19640
    v_mfma_f32_16x16x32_bf16 v[100:103], a[24:27], a[80:83], v[100:103]
    ds_read_b64_tr_b16 a[22:23], v6 offset:19360
    v_mfma_f32_16x16x32_bf16 v[44:47], a[28:31], a[76:79], v[44:47]
    ds_read_b64_tr_b16 a[24:25], v6 offset:15560
    ds_read_b64_tr_b16 a[72:73], v7 offset:15680
    v_mfma_f32_16x16x32_bf16 v[104:107], a[28:31], a[80:83], v[104:107]
    ds_read_b64_tr_b16 a[26:27], v6 offset:19400
    v_mfma_f32_16x16x32_bf16 v[48:51], a[32:35], a[76:79], v[48:51]
    ds_read_b64_tr_b16 a[28:29], v6 offset:15600
    ds_read_b64_tr_b16 a[74:75], v7 offset:19520
    v_mfma_f32_16x16x32_bf16 v[108:111], a[32:35], a[80:83], v[108:111]
    ds_read_b64_tr_b16 a[30:31], v6 offset:19440
    v_mfma_f32_16x16x32_bf16 v[52:55], a[36:39], a[76:79], v[52:55]
    ds_read_b64_tr_b16 a[32:33], v6 offset:15640
    ds_read_b128 a[100:103], v0 offset:64
    v_mfma_f32_16x16x32_bf16 v[112:115], a[36:39], a[80:83], v[112:115]
    ds_read_b64_tr_b16 a[34:35], v6 offset:19480
    v_mfma_f32_16x16x32_bf16 v[140:143], a[36:39], a[84:87], v[140:143]
    v_mfma_f32_16x16x32_bf16 v[56:59], a[76:79], a[40:43], v[56:59]
    ds_read_b64_tr_b16 a[36:37], v7 offset:15520
    v_mfma_f32_16x16x32_bf16 v[116:119], a[80:83], a[40:43], v[116:119]
    ds_read_b64_tr_b16 a[38:39], v7 offset:19360
    v_mfma_f32_16x16x32_bf16 v[60:63], a[76:79], a[44:47], v[60:63]
    ds_read_b64_tr_b16 a[40:41], v6 offset:15680
    v_mfma_f32_16x16x32_bf16 v[120:123], a[80:83], a[44:47], v[120:123]
    ds_read_b64_tr_b16 a[42:43], v6 offset:19520
    v_mfma_f32_16x16x32_bf16 v[64:67], a[76:79], a[48:51], v[64:67]
    s_add_u32 s71, s71, 49152
    s_cmp_eq_u32 s71, 147456
    v_mfma_f32_16x16x32_bf16 v[124:127], a[80:83], a[48:51], v[124:127]
    s_cselect_b32 s71, 0, s71
    v_add_u32 v6, s71, v2
    v_mfma_f32_16x16x32_bf16 v[68:71], a[76:79], a[52:55], v[68:71]
    v_add_u32 v7, s71, v3
    v_add_u32 v8, s71, v4
    v_mfma_f32_16x16x32_bf16 v[128:131], a[80:83], a[52:55], v[128:131]
    v_add_u32 v9, s71, v5
    v_add_u32 v0, 128, v0
    v_mfma_f32_16x16x32_bf16 v[144:147], a[84:87], a[52:55], v[144:147]
    s_cmp_eq_u32 s70, 9
    v_mfma_f32_16x16x32_bf16 v[72:75], a[76:79], a[56:59], v[72:75]
    v_mfma_f32_16x16x32_bf16 v[132:135], a[80:83], a[56:59], v[132:135]
    s_waitcnt lgkmcnt(0)
    s_barrier
    s_cbranch_scc1 L_last0
    v_mfma_f32_16x16x32_bf16 v[10:13], a[100:103], a[88:91], v[10:13]
    ds_read_b128 a[76:79], v8 offset:30720
    v_mfma_f32_16x16x32_bf16 v[148:151], a[100:103], a[92:95], v[148:151]
    ds_read_b128 a[80:83], v8 offset:32768
    v_mfma_f32_16x16x32_bf16 v[16:19], a[0:3], a[88:91], v[16:19]
    ds_read_b128 a[84:87], v8 offset:47104
    v_mfma_f32_16x16x32_bf16 v[76:79], a[0:3], a[92:95], v[76:79]
    v_mfma_f32_16x16x32_bf16 v[20:23], a[4:7], a[88:91], v[20:23]
    ds_read_b64_tr_b16 a[0:1], v6 offset:0
    ds_read_b64_tr_b16 a[44:45], v6 offset:360
    v_mfma_f32_16x16x32_bf16 v[80:83], a[4:7], a[92:95], v[80:83]
    ds_read_b64_tr_b16 a[2:3], v6 offset:3840
    v_mfma_f32_16x16x32_bf16 v[24:27], a[8:11], a[88:91], v[24:27]
    ds_read_b64_tr_b16 a[4:5], v6 offset:40
    ds_read_b64_tr_b16 a[46:47], v6 offset:4200
    v_mfma_f32_16x16x32_bf16 v[84:87], a[8:11], a[92:95], v[84:87]
    ds_read_b64_tr_b16 a[6:7], v6 offset:3880
    v_mfma_f32_16x16x32_bf16 v[28:31], a[12:15], a[88:91], v[28:31]
    ds_read_b64_tr_b16 a[8:9], v6 offset:80
    ds_read_b64_tr_b16 a[48:49], v6 offset:400
    v_mfma_f32_16x16x32_bf16 v[88:91], a[12:15], a[92:95], v[88:91]
    ds_read_b64_tr_b16 a[10:11], v6 offset:3920
    v_mfma_f32_16x16x32_bf16 v[32:35], a[16:19], a[88:91], v[32:35]
    ds_read_b64_tr_b16 a[12:13], v6 offset:120
    ds_read_b64_tr_b16 a[50:51], v6 offset:4240
    v_mfma_f32_16x16x32_bf16 v[92:95], a[16:19], a[92:95], v[92:95]
    ds_read_b64_tr_b16 a[14:15], v6 offset:3960
    v_mfma_f32_16x16x32_bf16 v[36:39], a[20:23], a[88:91], v[36:39]
    ds_read_b64_tr_b16 a[16:17], v7 offset:0
    ds_read_b64_tr_b16 a[52:53], v6 offset:440
    v_mfma_f32_16x16x32_bf16 v[96:99], a[20:23], a[92:95], v[96:99]
    ds_read_b64_tr_b16 a[18:19], v7 offset:3840
    v_mfma_f32_16x16x32_bf16 v[136:139], a[20:23], a[96:99], v[136:139]
    v_mfma_f32_16x16x32_bf16 v[40:43], a[24:27], a[88:91], v[40:43]
    ds_read_b64_tr_b16 a[20:21], v6 offset:160
    ds_read_b64_tr_b16 a[54:55], v6 offset:4280
    v_mfma_f32_16x16x32_bf16 v[100:103], a[24:27], a[92:95], v[100:103]
    ds_read_b64_tr_b16 a[22:23], v6 offset:4000
    v_mfma_f32_16x16x32_bf16 v[44:47], a[28:31], a[88:91], v[44:47]
    ds_read_b64_tr_b16 a[24:25], v6 offset:200
    ds_read_b64_tr_b16 a[56:57], v7 offset:320
    v_mfma_f32_16x16x32_bf16 v[104:107], a[28:31], a[92:95], v[104:107]
    ds_read_b64_tr_b16 a[26:27], v6 offset:4040
    v_mfma_f32_16x16x32_bf16 v[48:51], a[32:35], a[88:91], v[48:51]
    ds_read_b64_tr_b16 a[28:29], v6 offset:240
    ds_read_b64_tr_b16 a[58:59], v7 offset:4160
    v_mfma_f32_16x16x32_bf16 v[108:111], a[32:35], a[92:95], v[108:111]
    ds_read_b64_tr_b16 a[30:31], v6 offset:4080
    v_mfma_f32_16x16x32_bf16 v[52:55], a[36:39], a[88:91], v[52:55]
    ds_read_b64_tr_b16 a[32:33], v6 offset:280
    ds_read_b128 a[100:103], v0 offset:0
    v_mfma_f32_16x16x32_bf16 v[112:115], a[36:39], a[92:95], v[112:115]
    ds_read_b64_tr_b16 a[34:35], v6 offset:4120
    v_mfma_f32_16x16x32_bf16 v[140:143], a[36:39], a[96:99], v[140:143]
    v_mfma_f32_16x16x32_bf16 v[56:59], a[88:91], a[40:43], v[56:59]
    ds_read_b64_tr_b16 a[36:37], v7 offset:160
    v_mfma_f32_16x16x32_bf16 v[116:119], a[92:95], a[40:43], v[116:119]
    ds_read_b64_tr_b16 a[38:39], v7 offset:4000
    v_mfma_f32_16x16x32_bf16 v[60:63], a[88:91], a[60:63], v[60:63]
    ds_read_b64_tr_b16 a[40:41], v6 offset:320
    v_mfma_f32_16x16x32_bf16 v[120:123], a[92:95], a[60:63], v[120:123]
    ds_read_b64_tr_b16 a[42:43], v6 offset:4160
    v_mfma_f32_16x16x32_bf16 v[64:67], a[88:91], a[64:67], v[64:67]
    s_add_u32 s70, s70, 1
    v_mfma_f32_16x16x32_bf16 v[124:127], a[92:95], a[64:67], v[124:127]
    v_mfma_f32_16x16x32_bf16 v[68:71], a[88:91], a[68:71], v[68:71]
    v_mfma_f32_16x16x32_bf16 v[128:131], a[92:95], a[68:71], v[128:131]
    v_mfma_f32_16x16x32_bf16 v[144:147], a[96:99], a[68:71], v[144:147]
    v_mfma_f32_16x16x32_bf16 v[72:75], a[88:91], a[72:75], v[72:75]
    v_mfma_f32_16x16x32_bf16 v[132:135], a[92:95], a[72:75], v[132:135]
    s_waitcnt lgkmcnt(0)
    s_branch L_gl0
L_last0:
    v_mfma_f32_16x16x32_bf16 v[136:139], a[20:23], a[96:99], v[136:139]
    v_mfma_f32_16x16x32_bf16 v[140:143], a[36:39], a[96:99], v[140:143]
    v_mfma_f32_16x16x32_bf16 v[144:147], a[96:99], a[68:71], v[144:147]
    s_branch L_attn
L_g1:
    s_barrier
    ds_read_b128 a[76:79], v8 offset:34816
    ds_read_b128 a[80:83], v8 offset:36864
    ds_read_b128 a[84:87], v8 offset:47104
    ds_read_b128 a[100:103], v0
    ds_read_b64_tr_b16 a[0:1], v6 offset:0
    ds_read_b64_tr_b16 a[2:3], v6 offset:3840
    ds_read_b64_tr_b16 a[4:5], v6 offset:40
    ds_read_b64_tr_b16 a[6:7], v6 offset:3880
    ds_read_b64_tr_b16 a[8:9], v6 offset:80
    ds_read_b64_tr_b16 a[10:11], v6 offset:3920
    ds_read_b64_tr_b16 a[12:13], v6 offset:120
    ds_read_b64_tr_b16 a[14:15], v6 offset:3960
    ds_read_b64_tr_b16 a[16:17], v7 offset:0
    ds_read_b64_tr_b16 a[18:19], v7 offset:3840
    ds_read_b64_tr_b16 a[20:21], v6 offset:160
    ds_read_b64_tr_b16 a[22:23], v6 offset:4000
    ds_read_b64_tr_b16 a[24:25], v6 offset:200
    ds_read_b64_tr_b16 a[26:27], v6 offset:4040
    ds_read_b64_tr_b16 a[28:29], v6 offset:240
    ds_read_b64_tr_b16 a[30:31], v6 offset:4080
    ds_read_b64_tr_b16 a[32:33], v6 offset:280
    ds_read_b64_tr_b16 a[34:35], v6 offset:4120
    ds_read_b64_tr_b16 a[36:37], v7 offset:160
    ds_read_b64_tr_b16 a[38:39], v7 offset:4000
    ds_read_b64_tr_b16 a[40:41], v6 offset:320
    ds_read_b64_tr_b16 a[42:43], v6 offset:4160
    ds_read_b64_tr_b16 a[44:45], v6 offset:360
    ds_read_b64_tr_b16 a[46:47], v6 offset:4200
    ds_read_b64_tr_b16 a[48:49], v6 offset:400
    ds_read_b64_tr_b16 a[50:51], v6 offset:4240
    ds_read_b64_tr_b16 a[52:53], v6 offset:440
    ds_read_b64_tr_b16 a[54:55], v6 offset:4280
    ds_read_b64_tr_b16 a[56:57], v7 offset:320
    ds_read_b64_tr_b16 a[58:59], v7 offset:4160
    s_waitcnt lgkmcnt(0)
    .p2align 6
L_gl1:
    v_mfma_f32_16x16x32_bf16 v[10:13], a[100:103], a[76:79], v[10:13]
    ds_read_b128 a[88:91], v9 offset:34816
    v_mfma_f32_16x16x32_bf16 v[148:151], a[100:103], a[80:83], v[148:151]
    ds_read_b128 a[92:95], v9 offset:36864
    v_mfma_f32_16x16x32_bf16 v[16:19], a[0:3], a[76:79], v[16:19]
    ds_read_b128 a[96:99], v9 offset:47104
    v_mfma_f32_16x16x32_bf16 v[76:79], a[0:3], a[80:83], v[76:79]
    v_mfma_f32_16x16x32_bf16 v[20:23], a[4:7], a[76:79], v[20:23]
    ds_read_b64_tr_b16 a[0:1], v6 offset:15360
    ds_read_b64_tr_b16 a[60:61], v6 offset:15720
    v_mfma_f32_16x16x32_bf16 v[80:83], a[4:7], a[80:83], v[80:83]
    ds_read_b64_tr_b16 a[2:3], v6 offset:19200
    v_mfma_f32_16x16x32_bf16 v[24:27], a[8:11], a[76:79], v[24:27]
    ds_read_b64_tr_b16 a[4:5], v6 offset:15400
    ds_read_b64_tr_b16 a[62:63], v6 offset:19560
    v_mfma_f32_16x16x32_bf16 v[84:87], a[8:11], a[80:83], v[84:87]
    ds_read_b64_tr_b16 a[6:7], v6 offset:19240
    v_mfma_f32_16x16x32_bf16 v[28:31], a[12:15], a[76:79], v[28:31]
    ds_read_b64_tr_b16 a[8:9], v6 offset:15440
    ds_read_b64_tr_b16 a[64:65], v6 offset:15760
    v_mfma_f32_16x16x32_bf16 v[88:91], a[12:15], a[80:83], v[88:91]
    ds_read_b64_tr_b16 a[10:11], v6 offset:19280
    v_mfma_f32_16x16x32_bf16 v[32:35], a[16:19], a[76:79], v[32:35]
    ds_read_b64_tr_b16 a[12:13], v6 offset:15480
    ds_read_b64_tr_b16 a[66:67], v6 offset:19600
    v_mfma_f32_16x16x32_bf16 v[92:95], a[16:19], a[80:83], v[92:95]
    ds_read_b64_tr_b16 a[14:15], v6 offset:19320
    v_mfma_f32_16x16x32_bf16 v[36:39], a[20:23], a[76:79], v[36:39]
    ds_read_b64_tr_b16 a[16:17], v7 offset:15360
    ds_read_b64_tr_b16 a[68:69], v6 offset:15800
    v_mfma_f32_16x16x32_bf16 v[96:99], a[20:23], a[80:83], v[96:99]
    ds_read_b64_tr_b16 a[18:19], v7 offset:19200
    v_mfma_f32_16x16x32_bf16 v[40:43], a[24:27], a[76:79], v[40:43]
    ds_read_b64_tr_b16 a[20:21], v6 offset:15520
    ds_read_b64_tr_b16 a[70:71], v6 offset:19640
    v_mfma_f32_16x16x32_bf16 v[100:103], a[24:27], a[80:83], v[100:103]
    ds_read_b64_tr_b16 a[22:23], v6 offset:19360
    v_mfma_f32_16x16x32_bf16 v[136:139], a[24:27], a[84:87], v[136:139]
    v_mfma_f32_16x16x32_bf16 v[44:47], a[28:31], a[76:79], v[44:47]
    ds_read_b64_tr_b16 a[24:25], v6 offset:15560
    ds_read_b64_tr_b16 a[72:73], v7 offset:15680
    v_mfma_f32_16x16x32_bf16 v[104:107], a[28:31], a[80:83], v[104:107]
    ds_read_b64_tr_b16 a[26:27], v6 offset:19400
    v_mfma_f32_16x16x32_bf16 v[48:51], a[32:35], a[76:79], v[48:51]
    ds_read_b64_tr_b16 a[28:29], v6 offset:15600
    ds_read_b64_tr_b16 a[74:75], v7 offset:19520
    v_mfma_f32_16x16x32_bf16 v[108:111], a[32:35], a[80:83], v[108:111]
    ds_read_b64_tr_b16 a[30:31], v6 offset:19440
    v_mfma_f32_16x16x32_bf16 v[52:55], a[36:39], a[76:79], v[52:55]
    ds_read_b64_tr_b16 a[32:33], v6 offset:15640
    ds_read_b128 a[100:103], v0 offset:64
    v_mfma_f32_16x16x32_bf16 v[112:115], a[36:39], a[80:83], v[112:115]
    ds_read_b64_tr_b16 a[34:35], v6 offset:19480
    v_mfma_f32_16x16x32_bf16 v[56:59], a[76:79], a[40:43], v[56:59]
    ds_read_b64_tr_b16 a[36:37], v7 offset:15520
    v_mfma_f32_16x16x32_bf16 v[116:119], a[80:83], a[40:43], v[116:119]
    ds_read_b64_tr_b16 a[38:39], v7 offset:19360
    v_mfma_f32_16x16x32_bf16 v[140:143], a[84:87], a[40:43], v[140:143]
    v_mfma_f32_16x16x32_bf16 v[60:63], a[76:79], a[44:47], v[60:63]
    ds_read_b64_tr_b16 a[40:41], v6 offset:15680
    v_mfma_f32_16x16x32_bf16 v[120:123], a[80:83], a[44:47], v[120:123]
    ds_read_b64_tr_b16 a[42:43], v6 offset:19520
    v_mfma_f32_16x16x32_bf16 v[64:67], a[76:79], a[48:51], v[64:67]
    s_add_u32 s71, s71, 49152
    s_cmp_eq_u32 s71, 147456
    v_mfma_f32_16x16x32_bf16 v[124:127], a[80:83], a[48:51], v[124:127]
    s_cselect_b32 s71, 0, s71
    v_add_u32 v6, s71, v2
    v_mfma_f32_16x16x32_bf16 v[68:71], a[76:79], a[52:55], v[68:71]
    v_add_u32 v7, s71, v3
    v_add_u32 v8, s71, v4
    v_mfma_f32_16x16x32_bf16 v[128:131], a[80:83], a[52:55], v[128:131]
    v_add_u32 v9, s71, v5
    v_add_u32 v0, 128, v0
    v_mfma_f32_16x16x32_bf16 v[72:75], a[76:79], a[56:59], v[72:75]
    s_cmp_eq_u32 s70, 9
    v_mfma_f32_16x16x32_bf16 v[132:135], a[80:83], a[56:59], v[132:135]
    v_mfma_f32_16x16x32_bf16 v[144:147], a[84:87], a[56:59], v[144:147]
    s_waitcnt lgkmcnt(0)
    s_barrier
    s_cbranch_scc1 L_last1
    v_mfma_f32_16x16x32_bf16 v[10:13], a[100:103], a[88:91], v[10:13]
    ds_read_b128 a[76:79], v8 offset:34816
    v_mfma_f32_16x16x32_bf16 v[148:151], a[100:103], a[92:95], v[148:151]
    ds_read_b128 a[80:83], v8 offset:36864
    v_mfma_f32_16x16x32_bf16 v[16:19], a[0:3], a[88:91], v[16:19]
    ds_read_b128 a[84:87], v8 offset:47104
    v_mfma_f32_16x16x32_bf16 v[76:79], a[0:3], a[92:95], v[76:79]
    v_mfma_f32_16x16x32_bf16 v[20:23], a[4:7], a[88:91], v[20:23]
    ds_read_b64_tr_b16 a[0:1], v6 offset:0
    ds_read_b64_tr_b16 a[44:45], v6 offset:360
    v_mfma_f32_16x16x32_bf16 v[80:83], a[4:7], a[92:95], v[80:83]
    ds_read_b64_tr_b16 a[2:3], v6 offset:3840
    v_mfma_f32_16x16x32_bf16 v[24:27], a[8:11], a[88:91], v[24:27]
    ds_read_b64_tr_b16 a[4:5], v6 offset:40
    ds_read_b64_tr_b16 a[46:47], v6 offset:4200
    v_mfma_f32_16x16x32_bf16 v[84:87], a[8:11], a[92:95], v[84:87]
    ds_read_b64_tr_b16 a[6:7], v6 offset:3880
    v_mfma_f32_16x16x32_bf16 v[28:31], a[12:15], a[88:91], v[28:31]
    ds_read_b64_tr_b16 a[8:9], v6 offset:80
    ds_read_b64_tr_b16 a[48:49], v6 offset:400
    v_mfma_f32_16x16x32_bf16 v[88:91], a[12:15], a[92:95], v[88:91]
    ds_read_b64_tr_b16 a[10:11], v6 offset:3920
    v_mfma_f32_16x16x32_bf16 v[32:35], a[16:19], a[88:91], v[32:35]
    ds_read_b64_tr_b16 a[12:13], v6 offset:120
    ds_read_b64_tr_b16 a[50:51], v6 offset:4240
    v_mfma_f32_16x16x32_bf16 v[92:95], a[16:19], a[92:95], v[92:95]
    ds_read_b64_tr_b16 a[14:15], v6 offset:3960
    v_mfma_f32_16x16x32_bf16 v[36:39], a[20:23], a[88:91], v[36:39]
    ds_read_b64_tr_b16 a[16:17], v7 offset:0
    ds_read_b64_tr_b16 a[52:53], v6 offset:440
    v_mfma_f32_16x16x32_bf16 v[96:99], a[20:23], a[92:95], v[96:99]
    ds_read_b64_tr_b16 a[18:19], v7 offset:3840
    v_mfma_f32_16x16x32_bf16 v[40:43], a[24:27], a[88:91], v[40:43]
    ds_read_b64_tr_b16 a[20:21], v6 offset:160
    ds_read_b64_tr_b16 a[54:55], v6 offset:4280
    v_mfma_f32_16x16x32_bf16 v[100:103], a[24:27], a[92:95], v[100:103]
    ds_read_b64_tr_b16 a[22:23], v6 offset:4000
    v_mfma_f32_16x16x32_bf16 v[136:139], a[24:27], a[96:99], v[136:139]
    v_mfma_f32_16x16x32_bf16 v[44:47], a[28:31], a[88:91], v[44:47]
    ds_read_b64_tr_b16 a[24:25], v6 offset:200
    ds_read_b64_tr_b16 a[56:57], v7 offset:320
    v_mfma_f32_16x16x32_bf16 v[104:107], a[28:31], a[92:95], v[104:107]
    ds_read_b64_tr_b16 a[26:27], v6 offset:4040
    v_mfma_f32_16x16x32_bf16 v[48:51], a[32:35], a[88:91], v[48:51]
    ds_read_b64_tr_b16 a[28:29], v6 offset:240
    ds_read_b64_tr_b16 a[58:59], v7 offset:4160
    v_mfma_f32_16x16x32_bf16 v[108:111], a[32:35], a[92:95], v[108:111]
    ds_read_b64_tr_b16 a[30:31], v6 offset:4080
    v_mfma_f32_16x16x32_bf16 v[52:55], a[36:39], a[88:91], v[52:55]
    ds_read_b64_tr_b16 a[32:33], v6 offset:280
    ds_read_b128 a[100:103], v0 offset:0
    v_mfma_f32_16x16x32_bf16 v[112:115], a[36:39], a[92:95], v[112:115]
    ds_read_b64_tr_b16 a[34:35], v6 offset:4120
    v_mfma_f32_16x16x32_bf16 v[56:59], a[88:91], a[40:43], v[56:59]
    ds_read_b64_tr_b16 a[36:37], v7 offset:160
    v_mfma_f32_16x16x32_bf16 v[116:119], a[92:95], a[40:43], v[116:119]
    ds_read_b64_tr_b16 a[38:39], v7 offset:4000
    v_mfma_f32_16x16x32_bf16 v[140:143], a[96:99], a[40:43], v[140:143]
    v_mfma_f32_16x16x32_bf16 v[60:63], a[88:91], a[60:63], v[60:63]
    ds_read_b64_tr_b16 a[40:41], v6 offset:320
    v_mfma_f32_16x16x32_bf16 v[120:123], a[92:95], a[60:63], v[120:123]
    ds_read_b64_tr_b16 a[42:43], v6 offset:4160
    v_mfma_f32_16x16x32_bf16 v[64:67], a[88:91], a[64:67], v[64:67]
    s_add_u32 s70, s70, 1
    v_mfma_f32_16x16x32_bf16 v[124:127], a[92:95], a[64:67], v[124:127]
    v_mfma_f32_16x16x32_bf16 v[68:71], a[88:91], a[68:71], v[68:71]
    v_mfma_f32_16x16x32_bf16 v[128:131], a[92:95], a[68:71], v[128:131]
    v_mfma_f32_16x16x32_bf16 v[72:75], a[88:91], a[72:75], v[72:75]
    v_mfma_f32_16x16x32_bf16 v[132:135], a[92:95], a[72:75], v[132:135]
    v_mfma_f32_16x16x32_bf16 v[144:147], a[96:99], a[72:75], v[144:147]
    s_waitcnt lgkmcnt(0)
    s_branch L_gl1
L_last1:
    v_mfma_f32_16x16x32_bf16 v[136:139], a[24:27], a[96:99], v[136:139]
    v_mfma_f32_16x16x32_bf16 v[140:143], a[96:99], a[40:43], v[140:143]
    v_mfma_f32_16x16x32_bf16 v[144:147], a[96:99], a[72:75], v[144:147]
    s_branch L_attn
L_g2:
    s_barrier
    ds_read_b128 a[76:79], v8 offset:38912
    ds_read_b128 a[80:83], v8 offset:40960
    ds_read_b128 a[84:87], v8 offset:47104
    ds_read_b128 a[100:103], v0
    ds_read_b64_tr_b16 a[0:1], v6 offset:0
    ds_read_b64_tr_b16 a[2:3], v6 offset:3840
    ds_read_b64_tr_b16 a[4:5], v6 offset:40
    ds_read_b64_tr_b16 a[6:7], v6 offset:3880
    ds_read_b64_tr_b16 a[8:9], v6 offset:80
    ds_read_b64_tr_b16 a[10:11], v6 offset:3920
    ds_read_b64_tr_b16 a[12:13], v6 offset:120
    ds_read_b64_tr_b16 a[14:15], v6 offset:3960
    ds_read_b64_tr_b16 a[16:17], v7 offset:0
    ds_read_b64_tr_b16 a[18:19], v7 offset:3840
    ds_read_b64_tr_b16 a[20:21], v6 offset:160
    ds_read_b64_tr_b16 a[22:23], v6 offset:4000
    ds_read_b64_tr_b16 a[24:25], v6 offset:200
    ds_read_b64_tr_b16 a[26:27], v6 offset:4040
    ds_read_b64_tr_b16 a[28:29], v6 offset:240
    ds_read_b64_tr_b16 a[30:31], v6 offset:4080
    ds_read_b64_tr_b16 a[32:33], v6 offset:280
    ds_read_b64_tr_b16 a[34:35], v6 offset:4120
    ds_read_b64_tr_b16 a[36:37], v7 offset:160
    ds_read_b64_tr_b16 a[38:39], v7 offset:4000
    ds_read_b64_tr_b16 a[40:41], v6 offset:320
    ds_read_b64_tr_b16 a[42:43], v6 offset:4160
    ds_read_b64_tr_b16 a[44:45], v6 offset:360
    ds_read_b64_tr_b16 a[46:47], v6 offset:4200
    ds_read_b64_tr_b16 a[48:49], v6 offset:400
    ds_read_b64_tr_b16 a[50:51], v6 offset:4240
    ds_read_b64_tr_b16 a[52:53], v6 offset:440
    ds_read_b64_tr_b16 a[54:55], v6 offset:4280
    ds_read_b64_tr_b16 a[56:57], v7 offset:320
    ds_read_b64_tr_b16 a[58:59], v7 offset:4160
    s_waitcnt lgkmcnt(0)
    .p2align 6
L_gl2:
    v_mfma_f32_16x16x32_bf16 v[10:13], a[100:103], a[76:79], v[10:13]
    ds_read_b128 a[88:91], v9 offset:38912
    v_mfma_f32_16x16x32_bf16 v[148:151], a[100:103], a[80:83], v[148:151]
    ds_read_b128 a[92:95], v9 offset:40960
    v_mfma_f32_16x16x32_bf16 v[16:19], a[0:3], a[76:79], v[16:19]
    ds_read_b128 a[96:99], v9 offset:47104
    v_mfma_f32_16x16x32_bf16 v[76:79], a[0:3], a[80:83], v[76:79]
    v_mfma_f32_16x16x32_bf16 v[20:23], a[4:7], a[76:79], v[20:23]
    ds_read_b64_tr_b16 a[0:1], v6 offset:15360
    ds_read_b64_tr_b16 a[60:61], v6 offset:15720
    v_mfma_f32_16x16x32_bf16 v[80:83], a[4:7], a[80:83], v[80:83]
    ds_read_b64_tr_b16 a[2:3], v6 offset:19200
    v_mfma_f32_16x16x32_bf16 v[24:27], a[8:11], a[76:79], v[24:27]
    ds_read_b64_tr_b16 a[4:5], v6 offset:15400
    ds_read_b64_tr_b16 a[62:63], v6 offset:19560
    v_mfma_f32_16x16x32_bf16 v[84:87], a[8:11], a[80:83], v[84:87]
    ds_read_b64_tr_b16 a[6:7], v6 offset:19240
    v_mfma_f32_16x16x32_bf16 v[28:31], a[12:15], a[76:79], v[28:31]
    ds_read_b64_tr_b16 a[8:9], v6 offset:15440
    ds_read_b64_tr_b16 a[64:65], v6 offset:15760
    v_mfma_f32_16x16x32_bf16 v[88:91], a[12:15], a[80:83], v[88:91]
    ds_read_b64_tr_b16 a[10:11], v6 offset:19280
    v_mfma_f32_16x16x32_bf16 v[32:35], a[16:19], a[76:79], v[32:35]
    ds_read_b64_tr_b16 a[12:13], v6 offset:15480
    ds_read_b64_tr_b16 a[66:67], v6 offset:19600
    v_mfma_f32_16x16x32_bf16 v[92:95], a[16:19], a[80:83], v[92:95]
    ds_read_b64_tr_b16 a[14:15], v6 offset:19320
    v_mfma_f32_16x16x32_bf16 v[36:39], a[20:23], a[76:79], v[36:39]
    ds_read_b64_tr_b16 a[16:17], v7 offset:15360
    ds_read_b64_tr_b16 a[68:69], v6 offset:15800
    v_mfma_f32_16x16x32_bf16 v[96:99], a[20:23], a[80:83], v[96:99]
    ds_read_b64_tr_b16 a[18:19], v7 offset:19200
    v_mfma_f32_16x16x32_bf16 v[40:43], a[24:27], a[76:79], v[40:43]
    ds_read_b64_tr_b16 a[20:21], v6 offset:15520
    ds_read_b64_tr_b16 a[70:71], v6 offset:19640
    v_mfma_f32_16x16x32_bf16 v[100:103], a[24:27], a[80:83], v[100:103]
    ds_read_b64_tr_b16 a[22:23], v6 offset:19360
    v_mfma_f32_16x16x32_bf16 v[44:47], a[28:31], a[76:79], v[44:47]
    ds_read_b64_tr_b16 a[24:25], v6 offset:15560
    ds_read_b64_tr_b16 a[72:73], v7 offset:15680
    v_mfma_f32_16x16x32_bf16 v[104:107], a[28:31], a[80:83], v[104:107]
    ds_read_b64_tr_b16 a[26:27], v6 offset:19400
    v_mfma_f32_16x16x32_bf16 v[136:139], a[28:31], a[84:87], v[136:139]
    v_mfma_f32_16x16x32_bf16 v[48:51], a[32:35], a[76:79], v[48:51]
    ds_read_b64_tr_b16 a[28:29], v6 offset:15600
    ds_read_b64_tr_b16 a[74:75], v7 offset:19520
    v_mfma_f32_16x16x32_bf16 v[108:111], a[32:35], a[80:83], v[108:111]
    ds_read_b64_tr_b16 a[30:31], v6 offset:19440
    v_mfma_f32_16x16x32_bf16 v[52:55], a[36:39], a[76:79], v[52:55]
    ds_read_b64_tr_b16 a[32:33], v6 offset:15640
    ds_read_b128 a[100:103], v0 offset:64
    v_mfma_f32_16x16x32_bf16 v[112:115], a[36:39], a[80:83], v[112:115]
    ds_read_b64_tr_b16 a[34:35], v6 offset:19480
    v_mfma_f32_16x16x32_bf16 v[56:59], a[76:79], a[40:43], v[56:59]
    ds_read_b64_tr_b16 a[36:37], v7 offset:15520
    v_mfma_f32_16x16x32_bf16 v[116:119], a[80:83], a[40:43], v[116:119]
    ds_read_b64_tr_b16 a[38:39], v7 offset:19360
    v_mfma_f32_16x16x32_bf16 v[60:63], a[76:79], a[44:47], v[60:63]
    ds_read_b64_tr_b16 a[40:41], v6 offset:15680
    v_mfma_f32_16x16x32_bf16 v[120:123], a[80:83], a[44:47], v[120:123]
    ds_read_b64_tr_b16 a[42:43], v6 offset:19520
    v_mfma_f32_16x16x32_bf16 v[140:143], a[84:87], a[44:47], v[140:143]
    v_mfma_f32_16x16x32_bf16 v[64:67], a[76:79], a[48:51], v[64:67]
    s_add_u32 s71, s71, 49152
    s_cmp_eq_u32 s71, 147456
    v_mfma_f32_16x16x32_bf16 v[124:127], a[80:83], a[48:51], v[124:127]
    s_cselect_b32 s71, 0, s71
    v_add_u32 v6, s71, v2
    v_mfma_f32_16x16x32_bf16 v[68:71], a[76:79], a[52:55], v[68:71]
    v_add_u32 v7, s71, v3
    v_add_u32 v8, s71, v4
    v_mfma_f32_16x16x32_bf16 v[128:131], a[80:83], a[52:55], v[128:131]
    v_add_u32 v9, s71, v5
    v_add_u32 v0, 128, v0
    v_mfma_f32_16x16x32_bf16 v[72:75], a[76:79], a[56:59], v[72:75]
    s_cmp_eq_u32 s70, 9
    v_mfma_f32_16x16x32_bf16 v[132:135], a[80:83], a[56:59], v[132:135]
    s_waitcnt lgkmcnt(0)
    s_barrier
    s_cbranch_scc1 L_last2
    v_mfma_f32_16x16x32_bf16 v[10:13], a[100:103], a[88:91], v[10:13]
    ds_read_b128 a[76:79], v8 offset:38912
    v_mfma_f32_16x16x32_bf16 v[148:151], a[100:103], a[92:95], v[148:151]
    ds_read_b128 a[80:83], v8 offset:40960
    v_mfma_f32_16x16x32_bf16 v[16:19], a[0:3], a[88:91], v[16:19]
    ds_read_b128 a[84:87], v8 offset:47104
    v_mfma_f32_16x16x32_bf16 v[76:79], a[0:3], a[92:95], v[76:79]
    v_mfma_f32_16x16x32_bf16 v[20:23], a[4:7], a[88:91], v[20:23]
    ds_read_b64_tr_b16 a[0:1], v6 offset:0
    ds_read_b64_tr_b16 a[44:45], v6 offset:360
    v_mfma_f32_16x16x32_bf16 v[80:83], a[4:7], a[92:95], v[80:83]
    ds_read_b64_tr_b16 a[2:3], v6 offset:3840
    v_mfma_f32_16x16x32_bf16 v[24:27], a[8:11], a[88:91], v[24:27]
    ds_read_b64_tr_b16 a[4:5], v6 offset:40
    ds_read_b64_tr_b16 a[46:47], v6 offset:4200
    v_mfma_f32_16x16x32_bf16 v[84:87], a[8:11], a[92:95], v[84:87]
    ds_read_b64_tr_b16 a[6:7], v6 offset:3880
    v_mfma_f32_16x16x32_bf16 v[28:31], a[12:15], a[88:91], v[28:31]
    ds_read_b64_tr_b16 a[8:9], v6 offset:80
    ds_read_b64_tr_b16 a[48:49], v6 offset:400
    v_mfma_f32_16x16x32_bf16 v[88:91], a[12:15], a[92:95], v[88:91]
    ds_read_b64_tr_b16 a[10:11], v6 offset:3920
    v_mfma_f32_16x16x32_bf16 v[32:35], a[16:19], a[88:91], v[32:35]
    ds_read_b64_tr_b16 a[12:13], v6 offset:120
    ds_read_b64_tr_b16 a[50:51], v6 offset:4240
    v_mfma_f32_16x16x32_bf16 v[92:95], a[16:19], a[92:95], v[92:95]
    ds_read_b64_tr_b16 a[14:15], v6 offset:3960
    v_mfma_f32_16x16x32_bf16 v[36:39], a[20:23], a[88:91], v[36:39]
    ds_read_b64_tr_b16 a[16:17], v7 offset:0
    ds_read_b64_tr_b16 a[52:53], v6 offset:440
    v_mfma_f32_16x16x32_bf16 v[96:99], a[20:23], a[92:95], v[96:99]
    ds_read_b64_tr_b16 a[18:19], v7 offset:3840
    v_mfma_f32_16x16x32_bf16 v[40:43], a[24:27], a[88:91], v[40:43]
    ds_read_b64_tr_b16 a[20:21], v6 offset:160
    ds_read_b64_tr_b16 a[54:55], v6 offset:4280
    v_mfma_f32_16x16x32_bf16 v[100:103], a[24:27], a[92:95], v[100:103]
    ds_read_b64_tr_b16 a[22:23], v6 offset:4000
    v_mfma_f32_16x16x32_bf16 v[44:47], a[28:31], a[88:91], v[44:47]
    ds_read_b64_tr_b16 a[24:25], v6 offset:200
    ds_read_b64_tr_b16 a[56:57], v7 offset:320
    v_mfma_f32_16x16x32_bf16 v[104:107], a[28:31], a[92:95], v[104:107]
    ds_read_b64_tr_b16 a[26:27], v6 offset:4040
    v_mfma_f32_16x16x32_bf16 v[136:139], a[28:31], a[96:99], v[136:139]
    v_mfma_f32_16x16x32_bf16 v[48:51], a[32:35], a[88:91], v[48:51]
    ds_read_b64_tr_b16 a[28:29], v6 offset:240
    ds_read_b64_tr_b16 a[58:59], v7 offset:4160
    v_mfma_f32_16x16x32_bf16 v[108:111], a[32:35], a[92:95], v[108:111]
    ds_read_b64_tr_b16 a[30:31], v6 offset:4080
    v_mfma_f32_16x16x32_bf16 v[52:55], a[36:39], a[88:91], v[52:55]
    ds_read_b64_tr_b16 a[32:33], v6 offset:280
    ds_read_b128 a[100:103], v0 offset:0
    v_mfma_f32_16x16x32_bf16 v[112:115], a[36:39], a[92:95], v[112:115]
    ds_read_b64_tr_b16 a[34:35], v6 offset:4120
    v_mfma_f32_16x16x32_bf16 v[56:59], a[88:91], a[40:43], v[56:59]
    ds_read_b64_tr_b16 a[36:37], v7 offset:160
    v_mfma_f32_16x16x32_bf16 v[116:119], a[92:95], a[40:43], v[116:119]
    ds_read_b64_tr_b16 a[38:39], v7 offset:4000
    v_mfma_f32_16x16x32_bf16 v[60:63], a[88:91], a[60:63], v[60:63]
    ds_read_b64_tr_b16 a[40:41], v6 offset:320
    v_mfma_f32_16x16x32_bf16 v[120:123], a[92:95], a[60:63], v[120:123]
    ds_read_b64_tr_b16 a[42:43], v6 offset:4160
    v_mfma_f32_16x16x32_bf16 v[140:143], a[96:99], a[60:63], v[140:143]
    v_mfma_f32_16x16x32_bf16 v[64:67], a[88:91], a[64:67], v[64:67]
    s_add_u32 s70, s70, 1
    v_mfma_f32_16x16x32_bf16 v[124:127], a[92:95], a[64:67], v[124:127]
    v_mfma_f32_16x16x32_bf16 v[68:71], a[88:91], a[68:71], v[68:71]
    v_mfma_f32_16x16x32_bf16 v[128:131], a[92:95], a[68:71], v[128:131]
    v_mfma_f32_16x16x32_bf16 v[72:75], a[88:91], a[72:75], v[72:75]
    v_mfma_f32_16x16x32_bf16 v[132:135], a[92:95], a[72:75], v[132:135]
    s_waitcnt lgkmcnt(0)
    s_branch L_gl2
L_last2:
    v_mfma_f32_16x16x32_bf16 v[136:139], a[28:31], a[96:99], v[136:139]
    v_mfma_f32_16x16x32_bf16 v[140:143], a[96:99], a[60:63], v[140:143]
    s_branch L_attn
L_g3:
    s_barrier
    ds_read_b128 a[76:79], v8 offset:43008
    ds_read_b128 a[80:83], v8 offset:45056
    ds_read_b128 a[84:87], v8 offset:47104
    ds_read_b128 a[100:103], v0
    ds_read_b64_tr_b16 a[0:1], v6 offset:0
    ds_read_b64_tr_b16 a[2:3], v6 offset:3840
    ds_read_b64_tr_b16 a[4:5], v6 offset:40
    ds_read_b64_tr_b16 a[6:7], v6 offset:3880
    ds_read_b64_tr_b16 a[8:9], v6 offset:80
    ds_read_b64_tr_b16 a[10:11], v6 offset:3920
    ds_read_b64_tr_b16 a[12:13], v6 offset:120
    ds_read_b64_tr_b16 a[14:15], v6 offset:3960
    ds_read_b64_tr_b16 a[16:17], v7 offset:0
    ds_read_b64_tr_b16 a[18:19], v7 offset:3840
    ds_read_b64_tr_b16 a[20:21], v6 offset:160
    ds_read_b64_tr_b16 a[22:23], v6 offset:4000
    ds_read_b64_tr_b16 a[24:25], v6 offset:200
    ds_read_b64_tr_b16 a[26:27], v6 offset:4040
    ds_read_b64_tr_b16 a[28:29], v6 offset:240
    ds_read_b64_tr_b16 a[30:31], v6 offset:4080
    ds_read_b64_tr_b16 a[32:33], v6 offset:280
    ds_read_b64_tr_b16 a[34:35], v6 offset:4120
    ds_read_b64_tr_b16 a[36:37], v7 offset:160
    ds_read_b64_tr_b16 a[38:39], v7 offset:4000
    ds_read_b64_tr_b16 a[40:41], v6 offset:320
    ds_read_b64_tr_b16 a[42:43], v6 offset:4160
    ds_read_b64_tr_b16 a[44:45], v6 offset:360
    ds_read_b64_tr_b16 a[46:47], v6 offset:4200
    ds_read_b64_tr_b16 a[48:49], v6 offset:400
    ds_read_b64_tr_b16 a[50:51], v6 offset:4240
    ds_read_b64_tr_b16 a[52:53], v6 offset:440
    ds_read_b64_tr_b16 a[54:55], v6 offset:4280
    ds_read_b64_tr_b16 a[56:57], v7 offset:320
    ds_read_b64_tr_b16 a[58:59], v7 offset:4160
    s_waitcnt lgkmcnt(0)
    .p2align 6
L_gl3:
    v_mfma_f32_16x16x32_bf16 v[10:13], a[100:103], a[76:79], v[10:13]
    ds_read_b128 a[88:91], v9 offset:43008
    v_mfma_f32_16x16x32_bf16 v[148:151], a[100:103], a[80:83], v[148:151]
    ds_read_b128 a[92:95], v9 offset:45056
    v_mfma_f32_16x16x32_bf16 v[16:19], a[0:3], a[76:79], v[16:19]
    ds_read_b128 a[96:99], v9 offset:47104
    v_mfma_f32_16x16x32_bf16 v[76:79], a[0:3], a[80:83], v[76:79]
    v_mfma_f32_16x16x32_bf16 v[20:23], a[4:7], a[76:79], v[20:23]
    ds_read_b64_tr_b16 a[0:1], v6 offset:15360
    ds_read_b64_tr_b16 a[60:61], v6 offset:15720
    v_mfma_f32_16x16x32_bf16 v[80:83], a[4:7], a[80:83], v[80:83]
    ds_read_b64_tr_b16 a[2:3], v6 offset:19200
    v_mfma_f32_16x16x32_bf16 v[24:27], a[8:11], a[76:79], v[24:27]
    ds_read_b64_tr_b16 a[4:5], v6 offset:15400
    ds_read_b64_tr_b16 a[62:63], v6 offset:19560
    v_mfma_f32_16x16x32_bf16 v[84:87], a[8:11], a[80:83], v[84:87]
    ds_read_b64_tr_b16 a[6:7], v6 offset:19240
    v_mfma_f32_16x16x32_bf16 v[28:31], a[12:15], a[76:79], v[28:31]
    ds_read_b64_tr_b16 a[8:9], v6 offset:15440
    ds_read_b64_tr_b16 a[64:65], v6 offset:15760
    v_mfma_f32_16x16x32_bf16 v[88:91], a[12:15], a[80:83], v[88:91]
    ds_read_b64_tr_b16 a[10:11], v6 offset:19280
    v_mfma_f32_16x16x32_bf16 v[32:35], a[16:19], a[76:79], v[32:35]
    ds_read_b64_tr_b16 a[12:13], v6 offset:15480
    ds_read_b64_tr_b16 a[66:67], v6 offset:19600
    v_mfma_f32_16x16x32_bf16 v[92:95], a[16:19], a[80:83], v[92:95]
    ds_read_b64_tr_b16 a[14:15], v6 offset:19320
    v_mfma_f32_16x16x32_bf16 v[36:39], a[20:23], a[76:79], v[36:39]
    ds_read_b64_tr_b16 a[16:17], v7 offset:15360
    ds_read_b64_tr_b16 a[68:69], v6 offset:15800
    v_mfma_f32_16x16x32_bf16 v[96:99], a[20:23], a[80:83], v[96:99]
    ds_read_b64_tr_b16 a[18:19], v7 offset:19200
    v_mfma_f32_16x16x32_bf16 v[40:43], a[24:27], a[76:79], v[40:43]
    ds_read_b64_tr_b16 a[20:21], v6 offset:15520
    ds_read_b64_tr_b16 a[70:71], v6 offset:19640
    v_mfma_f32_16x16x32_bf16 v[100:103], a[24:27], a[80:83], v[100:103]
    ds_read_b64_tr_b16 a[22:23], v6 offset:19360
    v_mfma_f32_16x16x32_bf16 v[44:47], a[28:31], a[76:79], v[44:47]
    ds_read_b64_tr_b16 a[24:25], v6 offset:15560
    ds_read_b64_tr_b16 a[72:73], v7 offset:15680
    v_mfma_f32_16x16x32_bf16 v[104:107], a[28:31], a[80:83], v[104:107]
    ds_read_b64_tr_b16 a[26:27], v6 offset:19400
    v_mfma_f32_16x16x32_bf16 v[48:51], a[32:35], a[76:79], v[48:51]
    ds_read_b64_tr_b16 a[28:29], v6 offset:15600
    ds_read_b64_tr_b16 a[74:75], v7 offset:19520
    v_mfma_f32_16x16x32_bf16 v[108:111], a[32:35], a[80:83], v[108:111]
    ds_read_b64_tr_b16 a[30:31], v6 offset:19440
    v_mfma_f32_16x16x32_bf16 v[136:139], a[32:35], a[84:87], v[136:139]
    v_mfma_f32_16x16x32_bf16 v[52:55], a[36:39], a[76:79], v[52:55]
    ds_read_b64_tr_b16 a[32:33], v6 offset:15640
    ds_read_b128 a[100:103], v0 offset:64
    v_mfma_f32_16x16x32_bf16 v[112:115], a[36:39], a[80:83], v[112:115]
    ds_read_b64_tr_b16 a[34:35], v6 offset:19480
    v_mfma_f32_16x16x32_bf16 v[56:59], a[76:79], a[40:43], v[56:59]
    ds_read_b64_tr_b16 a[36:37], v7 offset:15520
    v_mfma_f32_16x16x32_bf16 v[116:119], a[80:83], a[40:43], v[116:119]
    ds_read_b64_tr_b16 a[38:39], v7 offset:19360
    v_mfma_f32_16x16x32_bf16 v[60:63], a[76:79], a[44:47], v[60:63]
    ds_read_b64_tr_b16 a[40:41], v6 offset:15680
    v_mfma_f32_16x16x32_bf16 v[120:123], a[80:83], a[44:47], v[120:123]
    ds_read_b64_tr_b16 a[42:43], v6 offset:19520
    v_mfma_f32_16x16x32_bf16 v[64:67], a[76:79], a[48:51], v[64:67]
    s_add_u32 s71, s71, 49152
    s_cmp_eq_u32 s71, 147456
    v_mfma_f32_16x16x32_bf16 v[124:127], a[80:83], a[48:51], v[124:127]
    s_cselect_b32 s71, 0, s71
    v_add_u32 v6, s71, v2
    v_mfma_f32_16x16x32_bf16 v[140:143], a[84:87], a[48:51], v[140:143]
    v_add_u32 v7, s71, v3
    v_add_u32 v8, s71, v4
    v_mfma_f32_16x16x32_bf16 v[68:71], a[76:79], a[52:55], v[68:71]
    v_add_u32 v9, s71, v5
    v_add_u32 v0, 128, v0
    v_mfma_f32_16x16x32_bf16 v[128:131], a[80:83], a[52:55], v[128:131]
    s_cmp_eq_u32 s70, 9
    v_mfma_f32_16x16x32_bf16 v[72:75], a[76:79], a[56:59], v[72:75]
    v_mfma_f32_16x16x32_bf16 v[132:135], a[80:83], a[56:59], v[132:135]
    s_waitcnt lgkmcnt(0)
    s_barrier
    s_cbranch_scc1 L_last3
    v_mfma_f32_16x16x32_bf16 v[10:13], a[100:103], a[88:91], v[10:13]
    ds_read_b128 a[76:79], v8 offset:43008
    v_mfma_f32_16x16x32_bf16 v[148:151], a[100:103], a[92:95], v[148:151]
    ds_read_b128 a[80:83], v8 offset:45056
    v_mfma_f32_16x16x32_bf16 v[16:19], a[0:3], a[88:91], v[16:19]
    ds_read_b128 a[84:87], v8 offset:47104
    v_mfma_f32_16x16x32_bf16 v[76:79], a[0:3], a[92:95], v[76:79]
    v_mfma_f32_16x16x32_bf16 v[20:23], a[4:7], a[88:91], v[20:23]
    ds_read_b64_tr_b16 a[0:1], v6 offset:0
    ds_read_b64_tr_b16 a[44:45], v6 offset:360
    v_mfma_f32_16x16x32_bf16 v[80:83], a[4:7], a[92:95], v[80:83]
    ds_read_b64_tr_b16 a[2:3], v6 offset:3840
    v_mfma_f32_16x16x32_bf16 v[24:27], a[8:11], a[88:91], v[24:27]
    ds_read_b64_tr_b16 a[4:5], v6 offset:40
    ds_read_b64_tr_b16 a[46:47], v6 offset:4200
    v_mfma_f32_16x16x32_bf16 v[84:87], a[8:11], a[92:95], v[84:87]
    ds_read_b64_tr_b16 a[6:7], v6 offset:3880
    v_mfma_f32_16x16x32_bf16 v[28:31], a[12:15], a[88:91], v[28:31]
    ds_read_b64_tr_b16 a[8:9], v6 offset:80
    ds_read_b64_tr_b16 a[48:49], v6 offset:400
    v_mfma_f32_16x16x32_bf16 v[88:91], a[12:15], a[92:95], v[88:91]
    ds_read_b64_tr_b16 a[10:11], v6 offset:3920
    v_mfma_f32_16x16x32_bf16 v[32:35], a[16:19], a[88:91], v[32:35]
    ds_read_b64_tr_b16 a[12:13], v6 offset:120
    ds_read_b64_tr_b16 a[50:51], v6 offset:4240
    v_mfma_f32_16x16x32_bf16 v[92:95], a[16:19], a[92:95], v[92:95]
    ds_read_b64_tr_b16 a[14:15], v6 offset:3960
    v_mfma_f32_16x16x32_bf16 v[36:39], a[20:23], a[88:91], v[36:39]
    ds_read_b64_tr_b16 a[16:17], v7 offset:0
    ds_read_b64_tr_b16 a[52:53], v6 offset:440
    v_mfma_f32_16x16x32_bf16 v[96:99], a[20:23], a[92:95], v[96:99]
    ds_read_b64_tr_b16 a[18:19], v7 offset:3840
    v_mfma_f32_16x16x32_bf16 v[40:43], a[24:27], a[88:91], v[40:43]
    ds_read_b64_tr_b16 a[20:21], v6 offset:160
    ds_read_b64_tr_b16 a[54:55], v6 offset:4280
    v_mfma_f32_16x16x32_bf16 v[100:103], a[24:27], a[92:95], v[100:103]
    ds_read_b64_tr_b16 a[22:23], v6 offset:4000
    v_mfma_f32_16x16x32_bf16 v[44:47], a[28:31], a[88:91], v[44:47]
    ds_read_b64_tr_b16 a[24:25], v6 offset:200
    ds_read_b64_tr_b16 a[56:57], v7 offset:320
    v_mfma_f32_16x16x32_bf16 v[104:107], a[28:31], a[92:95], v[104:107]
    ds_read_b64_tr_b16 a[26:27], v6 offset:4040
    v_mfma_f32_16x16x32_bf16 v[48:51], a[32:35], a[88:91], v[48:51]
    ds_read_b64_tr_b16 a[28:29], v6 offset:240
    ds_read_b64_tr_b16 a[58:59], v7 offset:4160
    v_mfma_f32_16x16x32_bf16 v[108:111], a[32:35], a[92:95], v[108:111]
    ds_read_b64_tr_b16 a[30:31], v6 offset:4080
    v_mfma_f32_16x16x32_bf16 v[136:139], a[32:35], a[96:99], v[136:139]
    v_mfma_f32_16x16x32_bf16 v[52:55], a[36:39], a[88:91], v[52:55]
    ds_read_b64_tr_b16 a[32:33], v6 offset:280
    ds_read_b128 a[100:103], v0 offset:0
    v_mfma_f32_16x16x32_bf16 v[112:115], a[36:39], a[92:95], v[112:115]
    ds_read_b64_tr_b16 a[34:35], v6 offset:4120
    v_mfma_f32_16x16x32_bf16 v[56:59], a[88:91], a[40:43], v[56:59]
    ds_read_b64_tr_b16 a[36:37], v7 offset:160
    v_mfma_f32_16x16x32_bf16 v[116:119], a[92:95], a[40:43], v[116:119]
    ds_read_b64_tr_b16 a[38:39], v7 offset:4000
    v_mfma_f32_16x16x32_bf16 v[60:63], a[88:91], a[60:63], v[60:63]
    ds_read_b64_tr_b16 a[40:41], v6 offset:320
    v_mfma_f32_16x16x32_bf16 v[120:123], a[92:95], a[60:63], v[120:123]
    ds_read_b64_tr_b16 a[42:43], v6 offset:4160
    v_mfma_f32_16x16x32_bf16 v[64:67], a[88:91], a[64:67], v[64:67]
    s_add_u32 s70, s70, 1
    v_mfma_f32_16x16x32_bf16 v[124:127], a[92:95], a[64:67], v[124:127]
    v_mfma_f32_16x16x32_bf16 v[140:143], a[96:99], a[64:67], v[140:143]
    v_mfma_f32_16x16x32_bf16 v[68:71], a[88:91], a[68:71], v[68:71]
    v_mfma_f32_16x16x32_bf16 v[128:131], a[92:95], a[68:71], v[128:131]
    v_mfma_f32_16x16x32_bf16 v[72:75], a[88:91], a[72:75], v[72:75]
    v_mfma_f32_16x16x32_bf16 v[132:135], a[92:95], a[72:75], v[132:135]
    s_waitcnt lgkmcnt(0)
    s_branch L_gl3
L_last3:
    v_mfma_f32_16x16x32_bf16 v[136:139], a[32:35], a[96:99], v[136:139]
    v_mfma_f32_16x16x32_bf16 v[140:143], a[96:99], a[64:67], v[140:143]
    .p2align 6
L_attn:
    v_mfma_f32_16x16x32_bf16 v[10:13], a[100:103], a[88:91], v[10:13]
    ds_read_b128 a[44:47], v14 offset:0
    v_xor_b32 v5, 63, v1
    v_mfma_f32_16x16x32_bf16 v[148:151], a[100:103], a[92:95], v[148:151]
    ds_read_b128 a[48:51], v14 offset:4096
    v_min_u32 v5, 1, v5
    v_mfma_f32_16x16x32_bf16 v[96:99], a[20:23], a[92:95], v[96:99]
    ds_read_b128 a[52:55], v14 offset:8192
    v_lshlrev_b32 v5, 30, v5
    v_mfma_f32_16x16x32_bf16 v[100:103], a[24:27], a[92:95], v[100:103]
    ds_read_b128 a[56:59], v14 offset:12288
    v_lshlrev_b32 v4, 4, v1
    v_mfma_f32_16x16x32_bf16 v[104:107], a[28:31], a[92:95], v[104:107]
    ds_read_b128 a[76:79], v14 offset:16384
    v_lshl_add_u32 v2, v1, 3, s13
    v_mfma_f32_16x16x32_bf16 v[108:111], a[32:35], a[92:95], v[108:111]
    ds_read_b128 a[80:83], v14 offset:20480
    v_lshl_add_u32 v6, v1, 3, s14
    v_mfma_f32_16x16x32_bf16 v[112:115], a[36:39], a[92:95], v[112:115]
    ds_read_b128 a[84:87], v14 offset:24576
    v_lshl_add_u32 v7, v1, 3, s15
    v_mfma_f32_16x16x32_bf16 v[36:39], a[20:23], a[88:91], v[36:39]
    ds_read_b128 a[96:99], v14 offset:28672
    v_lshl_add_u32 v3, v1, 3, s66
    v_mfma_f32_16x16x32_bf16 v[40:43], a[24:27], a[88:91], v[40:43]
    ds_read_b128 a[100:103], v14 offset:32768
    s_cmp_lt_u32 s62, 8
    v_mfma_f32_16x16x32_bf16 v[44:47], a[28:31], a[88:91], v[44:47]
    ds_read_b128 a[20:23], v14 offset:36864
    s_cselect_b64 vcc, -1, 0
    v_mfma_f32_16x16x32_bf16 v[48:51], a[32:35], a[88:91], v[48:51]
    ds_read_b128 a[24:27], v14 offset:40960
    v_cvt_pk_bf16_f32 v148, v10, v149
    v_mfma_f32_16x16x32_bf16 v[52:55], a[36:39], a[88:91], v[52:55]
    ds_read_b128 a[28:31], v14 offset:45056
    v_and_b32 v149, 0xffff0000, v148
    v_mfma_f32_16x16x32_bf16 v[76:79], a[0:3], a[92:95], v[76:79]
    ds_read_b128 a[32:35], v14 offset:49152
    v_lshlrev_b32 v148, 16, v148
    v_mfma_f32_16x16x32_bf16 v[80:83], a[4:7], a[92:95], v[80:83]
    ds_read_b128 a[36:39], v15 offset:0
    v_mul_f32 v148, 0xbfb8aa3b, v148
    v_mfma_f32_16x16x32_bf16 v[84:87], a[8:11], a[92:95], v[84:87]
    v_mul_f32 v149, 0xbfb8aa3b, v149
    v_exp_f32 v148, v148
    v_mfma_f32_16x16x32_bf16 v[88:91], a[12:15], a[92:95], v[88:91]
    v_exp_f32 v149, v149
    v_mfma_f32_16x16x32_bf16 v[92:95], a[16:19], a[92:95], v[92:95]
    v_add_f32 v148, 1.0, v148
    v_add_f32 v149, 1.0, v149
    v_mfma_f32_16x16x32_bf16 v[16:19], a[0:3], a[88:91], v[16:19]
    ds_read_b128 a[0:3], v15 offset:4096
    v_rcp_f32 v148, v148
    v_mfma_f32_16x16x32_bf16 v[116:119], a[92:95], a[40:43], v[116:119]
    v_rcp_f32 v149, v149
    v_mfma_f32_16x16x32_bf16 v[120:123], a[92:95], a[60:63], v[120:123]
    v_cvt_pk_bf16_f32 v150, v148, v149
    v_and_b32 v149, 0xffff0000, v150
    v_mfma_f32_16x16x32_bf16 v[124:127], a[92:95], a[64:67], v[124:127]
    v_lshlrev_b32 v148, 16, v150
    v_sub_f32 v148, 1.0, v148
    v_mfma_f32_16x16x32_bf16 v[128:131], a[92:95], a[68:71], v[128:131]
    v_sub_f32 v149, 1.0, v149
    v_cvt_pk_bf16_f32 v151, v148, v149
    v_mfma_f32_16x16x32_bf16 v[132:135], a[92:95], a[72:75], v[132:135]
    v_cndmask_b32 v150, v151, v150, vcc
    v_and_b32 v149, 0xffff0000, v150
    v_mfma_f32_16x16x32_bf16 v[56:59], a[88:91], a[40:43], v[56:59]
    v_lshlrev_b32 v148, 16, v150
    v_mov_b32 v0, 0xffff
    v_mfma_f32_16x16x32_bf16 v[60:63], a[88:91], a[60:63], v[60:63]
    v_cndmask_b32 v150, 0, v0, s[92:93]
    v_cndmask_b32 v151, 0, v0, s[96:97]
    v_mfma_f32_16x16x32_bf16 v[64:67], a[88:91], a[64:67], v[64:67]
    v_mov_b32 v0, 0xffff0000
    v_cndmask_b32 v10, 0, v0, s[94:95]
    v_mfma_f32_16x16x32_bf16 v[68:71], a[88:91], a[68:71], v[68:71]
    v_cndmask_b32 v11, 0, v0, s[98:99]
    v_or_b32 v150, v150, v10
    v_mfma_f32_16x16x32_bf16 v[72:75], a[88:91], a[72:75], v[72:75]
    v_or_b32 v151, v151, v11
    v_mov_b32 v0, 0xff800000
    v_mfma_f32_16x16x32_bf16 v[20:23], a[4:7], a[88:91], v[20:23]
    v_cndmask_b32 v10, v0, 0, s[0:1]
    v_cndmask_b32 v11, v0, 0, s[6:7]
    v_mfma_f32_16x16x32_bf16 v[24:27], a[8:11], a[88:91], v[24:27]
    v_cndmask_b32 v12, v0, 0, s[44:45]
    v_cndmask_b32 v13, v0, 0, s[46:47]
    v_mfma_f32_16x16x32_bf16 v[28:31], a[12:15], a[88:91], v[28:31]
    v_lshrrev_b32 v0, 5, v1
    v_lshl_or_b32 v0, v0, 30, v4
    v_mfma_f32_16x16x32_bf16 v[32:35], a[16:19], a[88:91], v[32:35]
    v_cvt_pk_bf16_f32 v136, v136, v137
    v_cvt_pk_bf16_f32 v137, v138, v139
    v_cvt_pk_bf16_f32 v138, v140, v141
    v_cvt_pk_bf16_f32 v139, v142, v143
    v_cvt_pk_bf16_f32 v140, v144, v145
    v_cvt_pk_bf16_f32 v141, v146, v147
    v_cvt_pk_bf16_f32 v142, v96, v97
    v_cvt_pk_bf16_f32 v143, v98, v99
    v_cvt_pk_bf16_f32 v146, v100, v101
    v_cvt_pk_bf16_f32 v147, v102, v103
    v_cvt_pk_bf16_f32 v144, v112, v113
    v_cvt_pk_bf16_f32 v145, v114, v115
    v_cvt_pk_bf16_f32 v96, v104, v105
    v_cvt_pk_bf16_f32 v97, v106, v107
    v_cvt_pk_bf16_f32 v100, v108, v109
    v_cvt_pk_bf16_f32 v101, v110, v111
    v_cvt_pk_bf16_f32 v98, v112, v113
    v_cvt_pk_bf16_f32 v99, v114, v115
    v_cvt_pk_bf16_f32 v106, v116, v117
    v_cvt_pk_bf16_f32 v107, v118, v119
    v_cvt_pk_bf16_f32 v112, v120, v121
    v_cvt_pk_bf16_f32 v113, v122, v123
    v_cvt_pk_bf16_f32 v118, v124, v125
    v_cvt_pk_bf16_f32 v119, v126, v127
    v_cvt_pk_bf16_f32 v124, v128, v129
    v_cvt_pk_bf16_f32 v125, v130, v131
    v_cvt_pk_bf16_f32 v130, v132, v133
    v_cvt_pk_bf16_f32 v131, v134, v135
    s_waitcnt lgkmcnt(0)
    s_barrier
    v_cvt_pk_bf16_f32 v104, v56, v57
    v_cvt_pk_bf16_f32 v105, v58, v59
    v_cvt_pk_bf16_f32 v110, v60, v61
    v_cvt_pk_bf16_f32 v111, v62, v63
    v_cvt_pk_bf16_f32 v116, v64, v65
    v_cvt_pk_bf16_f32 v117, v66, v67
    v_cvt_pk_bf16_f32 v122, v68, v69
    v_cvt_pk_bf16_f32 v123, v70, v71
    v_cvt_pk_bf16_f32 v128, v72, v73
    v_cvt_pk_bf16_f32 v129, v74, v75
    v_cvt_pk_bf16_f32 v56, v36, v37
    v_cvt_pk_bf16_f32 v57, v38, v39
    v_cvt_pk_bf16_f32 v60, v40, v41
    v_cvt_pk_bf16_f32 v61, v42, v43
    v_cvt_pk_bf16_f32 v58, v52, v53
    v_cvt_pk_bf16_f32 v59, v54, v55
    v_cvt_pk_bf16_f32 v62, v44, v45
    v_cvt_pk_bf16_f32 v63, v46, v47
    v_cvt_pk_bf16_f32 v66, v48, v49
    v_cvt_pk_bf16_f32 v67, v50, v51
    v_cvt_pk_bf16_f32 v64, v52, v53
    v_cvt_pk_bf16_f32 v65, v54, v55
    v_cvt_pk_bf16_f32 v8, v92, v93
    v_cvt_pk_bf16_f32 v9, v94, v95
    v_cvt_pk_bf16_f32 v132, v76, v77
    v_cvt_pk_bf16_f32 v133, v78, v79
    v_cndmask_b32 v134, 0, v8, s[32:33]
    v_cndmask_b32 v135, 0, v9, s[32:33]
    v_cvt_pk_bf16_f32 v70, v80, v81
    v_cvt_pk_bf16_f32 v71, v82, v83
    v_mfma_f32_16x16x32_bf16 v[40:43], v[142:145], v[132:135], v[10:13]
    v_cndmask_b32 v68, 0, v8, s[34:35]
    v_cndmask_b32 v69, 0, v9, s[34:35]
    v_mfma_f32_16x16x32_bf16 v[76:79], v[56:59], v[132:135], 0
    v_cvt_pk_bf16_f32 v72, v84, v85
    v_cvt_pk_bf16_f32 v73, v86, v87
    v_mfma_f32_16x16x32_bf16 v[44:47], v[144:147], v[68:71], v[10:13]
    v_cndmask_b32 v74, 0, v8, s[36:37]
    v_cndmask_b32 v75, 0, v9, s[36:37]
    v_mfma_f32_16x16x32_bf16 v[80:83], v[58:61], v[68:71], 0
    v_cvt_pk_bf16_f32 v38, v88, v89
    v_cvt_pk_bf16_f32 v39, v90, v91
    v_mfma_f32_16x16x32_bf16 v[48:51], v[96:99], v[72:75], v[10:13]
    v_cndmask_b32 v36, 0, v8, s[38:39]
    v_cndmask_b32 v37, 0, v9, s[38:39]
    v_mfma_f32_16x16x32_bf16 v[84:87], v[62:65], v[72:75], 0
    v_cndmask_b32 v40, v40, v76, s[92:93]
    v_cndmask_b32 v41, v41, v77, s[94:95]
    v_mfma_f32_16x16x32_bf16 v[52:55], v[98:101], v[36:39], v[10:13]
    v_cndmask_b32 v42, v42, v78, s[96:97]
    v_cndmask_b32 v43, v43, v79, s[98:99]
    v_mfma_f32_16x16x32_bf16 v[88:91], v[64:67], v[36:39], 0
    v_max3_f32 v92, v40, v41, v42
    v_max_f32 v92, v92, v43
    v_cndmask_b32 v44, v44, v80, s[92:93]
    v_cndmask_b32 v45, v45, v81, s[94:95]
    v_cndmask_b32 v46, v46, v82, s[96:97]
    v_cndmask_b32 v47, v47, v83, s[98:99]
    v_max3_f32 v93, v44, v45, v46
    v_max_f32 v93, v93, v47
    v_cndmask_b32 v48, v48, v84, s[92:93]
    v_cndmask_b32 v49, v49, v85, s[94:95]
    v_cndmask_b32 v50, v50, v86, s[96:97]
    v_cndmask_b32 v51, v51, v87, s[98:99]
    v_max3_f32 v94, v48, v49, v50
    v_max_f32 v94, v94, v51
    v_cndmask_b32 v52, v52, v88, s[92:93]
    v_cndmask_b32 v53, v53, v89, s[94:95]
    v_cndmask_b32 v54, v54, v90, s[96:97]
    v_cndmask_b32 v55, v55, v91, s[98:99]
    v_max3_f32 v95, v52, v53, v54
    v_max_f32 v95, v95, v55
    v_permlane16_swap_b32 v92, v93
    v_max_f32 v92, v92, v93
    v_permlane16_swap_b32 v94, v95
    v_max_f32 v94, v94, v95
    v_cvt_pk_bf16_f32 v8, v32, v33
    v_cvt_pk_bf16_f32 v9, v34, v35
    v_permlane32_swap_b32 v92, v94
    v_max_f32 v92, v92, v94
    v_mul_f32 v92, s101, v92
    v_mov_b32 v94, v92
    s_nop 1
    v_permlane32_swap_b32 v92, v94
    v_mov_b32 v93, v92
    v_mov_b32 v95, v94
    s_nop 0
    v_permlane16_swap_b32 v92, v93
    v_pk_fma_f32 v[40:41], v[40:41], s[68:69], v[92:93] op_sel:[0,0,0] op_sel_hi:[1,1,0]
    v_permlane16_swap_b32 v94, v95
    v_pk_fma_f32 v[42:43], v[42:43], s[68:69], v[92:93] op_sel:[0,0,0] op_sel_hi:[1,1,0]
    v_pk_fma_f32 v[44:45], v[44:45], s[68:69], v[92:93] op_sel:[0,0,1] op_sel_hi:[1,1,1]
    v_pk_fma_f32 v[46:47], v[46:47], s[68:69], v[92:93] op_sel:[0,0,1] op_sel_hi:[1,1,1]
    v_pk_fma_f32 v[48:49], v[48:49], s[68:69], v[94:95] op_sel:[0,0,0] op_sel_hi:[1,1,0]
    v_pk_fma_f32 v[50:51], v[50:51], s[68:69], v[94:95] op_sel:[0,0,0] op_sel_hi:[1,1,0]
    v_pk_fma_f32 v[52:53], v[52:53], s[68:69], v[94:95] op_sel:[0,0,1] op_sel_hi:[1,1,1]
    v_pk_fma_f32 v[54:55], v[54:55], s[68:69], v[94:95] op_sel:[0,0,1] op_sel_hi:[1,1,1]
    v_exp_f32 v40, v40
    v_exp_f32 v41, v41
    v_exp_f32 v42, v42
    v_exp_f32 v43, v43
    v_exp_f32 v44, v44
    v_exp_f32 v45, v45
    v_exp_f32 v46, v46
    v_exp_f32 v47, v47
    v_exp_f32 v48, v48
    v_exp_f32 v49, v49
    v_exp_f32 v50, v50
    v_exp_f32 v51, v51
    v_exp_f32 v52, v52
    v_exp_f32 v53, v53
    v_exp_f32 v54, v54
    v_exp_f32 v55, v55
    v_pk_add_f32 v[76:77], v[40:41], v[42:43]
    v_pk_add_f32 v[80:81], v[44:45], v[46:47]
    v_pk_add_f32 v[84:85], v[48:49], v[50:51]
    v_pk_add_f32 v[88:89], v[52:53], v[54:55]
    v_add_f32 v92, v76, v77
    v_add_f32 v93, v80, v81
    v_add_f32 v94, v84, v85
    v_add_f32 v95, v88, v89
    v_permlane16_swap_b32 v92, v93
    v_add_f32 v92, v92, v93
    v_permlane16_swap_b32 v94, v95
    v_add_f32 v94, v94, v95
    s_nop 1
    v_permlane32_swap_b32 v92, v94
    v_add_f32 v92, v92, v94
    v_rcp_f32 v92, v92
    s_nop 0
    v_mul_f32 v92, v92, v149
    v_mov_b32 v94, v92
    s_nop 1
    v_permlane32_swap_b32 v92, v94
    v_mov_b32 v93, v92
    v_mov_b32 v95, v94
    s_nop 0
    v_permlane16_swap_b32 v92, v93
    v_pk_mul_f32 v[40:41], v[40:41], v[92:93] op_sel:[0,0] op_sel_hi:[1,0]
    v_permlane16_swap_b32 v94, v95
    v_pk_mul_f32 v[42:43], v[42:43], v[92:93] op_sel:[0,0] op_sel_hi:[1,0]
    v_cvt_pk_bf16_f32 v78, v40, v41
    v_cvt_pk_bf16_f32 v79, v42, v43
    v_and_b32 v76, v78, v150
    v_and_b32 v77, v79, v151
    v_xor_b32 v78, v78, v76
    v_xor_b32 v79, v79, v77
    v_pk_mul_f32 v[44:45], v[44:45], v[92:93] op_sel:[0,1] op_sel_hi:[1,1]
    v_pk_mul_f32 v[46:47], v[46:47], v[92:93] op_sel:[0,1] op_sel_hi:[1,1]
    v_mfma_f32_16x16x32_bf16 v[40:43], v[104:107], v[76:79], 0
    v_cvt_pk_bf16_f32 v82, v44, v45
    v_cvt_pk_bf16_f32 v83, v46, v47
    v_mfma_f32_16x16x32_bf16 v[132:135], v[128:131], v[76:79], 0
    v_and_b32 v80, v82, v150
    v_and_b32 v81, v83, v151
    v_xor_b32 v82, v82, v80
    v_xor_b32 v83, v83, v81
    v_pk_mul_f32 v[48:49], v[48:49], v[94:95] op_sel:[0,0] op_sel_hi:[1,0]
    v_pk_mul_f32 v[50:51], v[50:51], v[94:95] op_sel:[0,0] op_sel_hi:[1,0]
    v_mfma_f32_16x16x32_bf16 v[44:47], v[110:113], v[80:83], 0
    v_cvt_pk_bf16_f32 v86, v48, v49
    v_cvt_pk_bf16_f32 v87, v50, v51
    v_mfma_f32_16x16x32_bf16 v[68:71], v[128:131], v[80:83], 0
    v_and_b32 v84, v86, v150
    v_and_b32 v85, v87, v151
    v_xor_b32 v86, v86, v84
    v_xor_b32 v87, v87, v85
    v_pk_mul_f32 v[52:53], v[52:53], v[94:95] op_sel:[0,1] op_sel_hi:[1,1]
    v_pk_mul_f32 v[54:55], v[54:55], v[94:95] op_sel:[0,1] op_sel_hi:[1,1]
    v_mfma_f32_16x16x32_bf16 v[48:51], v[116:119], v[84:87], 0
    v_cvt_pk_bf16_f32 v90, v52, v53
    v_cvt_pk_bf16_f32 v91, v54, v55
    v_mfma_f32_16x16x32_bf16 v[72:75], v[128:131], v[84:87], 0
    v_and_b32 v88, v90, v150
    v_and_b32 v89, v91, v151
    v_xor_b32 v90, v90, v88
    v_xor_b32 v91, v91, v89
    v_cvt_pk_bf16_f32 v76, v40, v41
    v_cvt_pk_bf16_f32 v77, v42, v43
    v_mfma_f32_16x16x32_bf16 v[52:55], v[122:125], v[88:91], 0
    v_cvt_pk_bf16_f32 v78, v44, v45
    v_cvt_pk_bf16_f32 v79, v46, v47
    v_mfma_f32_16x16x32_bf16 v[36:39], v[128:131], v[88:91], 0
    v_add_u32 v82, v76, v77
    v_add3_u32 v82, v78, v79, v82
    v_cvt_pk_bf16_f32 v84, v48, v49
    v_cvt_pk_bf16_f32 v85, v50, v51
    v_add3_u32 v82, v84, v85, v82
    v_cvt_pk_bf16_f32 v86, v52, v53
    v_cvt_pk_bf16_f32 v87, v54, v55
    v_add3_u32 v82, v86, v87, v82
    v_mov_b32_dpp v132, v68 quad_perm:[0,1,2,3] row_mask:0x2 bank_mask:0xf
    v_mov_b32_dpp v133, v69 quad_perm:[0,1,2,3] row_mask:0x2 bank_mask:0xf
    v_mov_b32_dpp v134, v70 quad_perm:[0,1,2,3] row_mask:0x2 bank_mask:0xf
    v_mov_b32_dpp v135, v71 quad_perm:[0,1,2,3] row_mask:0x2 bank_mask:0xf
    v_mov_b32_dpp v132, v72 quad_perm:[0,1,2,3] row_mask:0x4 bank_mask:0xf
    v_mov_b32_dpp v133, v73 quad_perm:[0,1,2,3] row_mask:0x4 bank_mask:0xf
    v_mov_b32_dpp v134, v74 quad_perm:[0,1,2,3] row_mask:0x4 bank_mask:0xf
    v_mov_b32_dpp v135, v75 quad_perm:[0,1,2,3] row_mask:0x4 bank_mask:0xf
    v_mov_b32_dpp v132, v36 quad_perm:[0,1,2,3] row_mask:0x8 bank_mask:0xf
    v_mov_b32_dpp v133, v37 quad_perm:[0,1,2,3] row_mask:0x8 bank_mask:0xf
    v_mov_b32_dpp v134, v38 quad_perm:[0,1,2,3] row_mask:0x8 bank_mask:0xf
    v_mov_b32_dpp v135, v39 quad_perm:[0,1,2,3] row_mask:0x8 bank_mask:0xf
    v_cvt_pk_bf16_f32 v80, v132, v133
    v_cvt_pk_bf16_f32 v81, v134, v135
    v_add3_u32 v89, v80, v81, v82
    v_permlane32_swap_b32 v80, v82
    v_permlane32_swap_b32 v81, v83
    v_mov_b32 v88, s10
    v_add_u32_dpp v89, v89, v89 row_shr:1 row_mask:0xf bank_mask:0xf bound_ctrl:0
    v_cvt_pk_bf16_f32 v92, v16, v17
    v_cvt_pk_bf16_f32 v93, v18, v19
    v_add_u32_dpp v89, v89, v89 row_shr:2 row_mask:0xf bank_mask:0xf bound_ctrl:0
    v_cndmask_b32 v94, 0, v8, s[32:33]
    v_cndmask_b32 v95, 0, v9, s[32:33]
    v_add_u32_dpp v89, v89, v89 row_shr:4 row_mask:0xf bank_mask:0xf bound_ctrl:0
    v_cvt_pk_bf16_f32 v42, v20, v21
    v_mfma_f32_16x16x32_bf16 v[44:47], v[56:59], v[92:95], v[10:13]
    v_add_u32_dpp v89, v89, v89 row_shr:8 row_mask:0xf bank_mask:0xf bound_ctrl:0
    v_cvt_pk_bf16_f32 v43, v22, v23
    v_cndmask_b32 v40, 0, v8, s[34:35]
    v_add_u32_dpp v89, v89, v89 row_bcast:15 row_mask:0xa bank_mask:0xf
    v_cndmask_b32 v41, 0, v9, s[34:35]
    v_cvt_pk_bf16_f32 v134, v28, v29
    v_add_u32_dpp v89, v89, v89 row_bcast:31 row_mask:0xc bank_mask:0xf
    v_cvt_pk_bf16_f32 v135, v30, v31
    v_cndmask_b32 v132, 0, v8, s[38:39]
    v_cndmask_b32 v133, 0, v9, s[38:39]
    s_nop 1
    v_mfma_f32_16x16x32_bf16 v[48:51], v[64:67], v[132:135], v[10:13]
    s_barrier
    buffer_store_dwordx4 v[80:83], v0, s[40:43], s67 offen offset:2048 sc1
    buffer_store_dwordx4 v[76:79], v4, s[40:43], s67 offen offset:0 sc1
    buffer_store_dwordx4 v[84:87], v4, s[40:43], s67 offen offset:1024 sc1
    buffer_store_dwordx2 v[88:89], v5, s[40:43], s56 offen offset:128 sc1
    ds_read_b128 a[4:7], v15 offset:8192
    v_mfma_f32_16x16x32_bf16 v[80:83], v[58:61], v[40:43], v[10:13]
    v_cvt_pk_bf16_f32 v76, v24, v25
    ds_read_b128 a[8:11], v15 offset:12288
    v_cvt_pk_bf16_f32 v77, v26, v27
    v_cndmask_b32 v78, 0, v8, s[36:37]
    v_cndmask_b32 v79, 0, v9, s[36:37]
    ds_read_b128 a[12:15], v15 offset:16384
    s_nop 0
    v_mfma_f32_16x16x32_bf16 v[68:71], v[62:65], v[76:79], v[10:13]
    ds_read_b128 a[16:19], v15 offset:20480
    ds_read_b128 a[40:43], v15 offset:24576
    ds_read_b128 a[60:63], v15 offset:28672
    ds_read_b128 a[64:67], v15 offset:32768
    ds_read_b128 a[68:71], v15 offset:36864
    ds_read_b128 a[72:75], v15 offset:40960
    ds_read_b128 a[88:91], v15 offset:45056
    ds_write2st64_b64 v2, v[136:137], v[138:139] offset0:0 offset1:4
    ds_write_b64 v6, v[140:141] offset:4096
    ds_write2st64_b64 v7, v[142:143], v[146:147] offset0:10 offset1:11
    ds_write2st64_b64 v7, v[96:97], v[100:101] offset0:12 offset1:13
    ds_write2st64_b64 v7, v[144:145], v[106:107] offset0:14 offset1:15
    ds_write2st64_b64 v7, v[112:113], v[118:119] offset0:16 offset1:17
    ds_write2st64_b64 v7, v[124:125], v[130:131] offset0:18 offset1:19
    s_waitcnt lgkmcnt(0)
    s_barrier
    ds_read2st64_b64 v[142:145], v3 offset0:0 offset1:4
    ds_read_b64 v[146:147], v3 offset:512
    ds_read2st64_b64 v[96:99], v3 offset0:2 offset1:4
    ds_read_b64 v[100:101], v3 offset:1536
    s_waitcnt lgkmcnt(0)
    ds_read_b64 v[102:103], v3 offset:2560
    v_mfma_f32_16x16x32_bf16 v[84:87], v[142:145], v[92:95], 0
    ds_read_b64 v[108:109], v3 offset:3072
    ds_read_b64 v[114:115], v3 offset:3584
    v_mfma_f32_16x16x32_bf16 v[72:75], v[144:147], v[40:43], 0
    ds_read_b64 v[120:121], v3 offset:4096
    ds_read_b64 v[126:127], v3 offset:4608
    v_mfma_f32_16x16x32_bf16 v[52:55], v[96:99], v[76:79], 0
    v_mfma_f32_16x16x32_bf16 v[88:91], v[98:101], v[132:135], 0
    s_nop 0
    v_cndmask_b32 v44, v44, v84, s[24:25]
    v_cndmask_b32 v45, v45, v85, s[26:27]
    v_cndmask_b32 v46, v46, v86, s[28:29]
    v_cndmask_b32 v47, v47, v87, s[30:31]
    v_max3_f32 v36, v44, v45, v46
    v_max_f32 v36, v36, v47
    v_cndmask_b32 v80, v80, v72, s[24:25]
    v_cndmask_b32 v81, v81, v73, s[26:27]
    v_cndmask_b32 v82, v82, v74, s[28:29]
    v_cndmask_b32 v83, v83, v75, s[30:31]
    v_max3_f32 v37, v80, v81, v82
    v_max_f32 v37, v37, v83
    v_cndmask_b32 v68, v68, v52, s[24:25]
    v_cndmask_b32 v69, v69, v53, s[26:27]
    v_cndmask_b32 v70, v70, v54, s[28:29]
    v_cndmask_b32 v71, v71, v55, s[30:31]
    v_max3_f32 v38, v68, v69, v70
    v_max_f32 v38, v38, v71
    s_waitcnt lgkmcnt(0)
    v_cndmask_b32 v48, v48, v88, s[24:25]
    v_cndmask_b32 v49, v49, v89, s[26:27]
    v_cndmask_b32 v50, v50, v90, s[28:29]
    v_cndmask_b32 v51, v51, v91, s[30:31]
    v_max3_f32 v39, v48, v49, v50
    v_max_f32 v39, v39, v51
    v_permlane16_swap_b32 v36, v37
    v_max_f32 v36, v36, v37
    v_permlane16_swap_b32 v38, v39
    v_max_f32 v38, v38, v39
    s_nop 1
    v_permlane32_swap_b32 v36, v38
    v_max_f32 v36, v36, v38
    v_mul_f32 v36, s101, v36
    v_mov_b32 v38, v36
    s_nop 1
    v_permlane32_swap_b32 v36, v38
    v_mov_b32 v37, v36
    v_mov_b32 v39, v38
    s_nop 0
    v_permlane16_swap_b32 v36, v37
    v_pk_fma_f32 v[44:45], v[44:45], s[68:69], v[36:37] op_sel:[0,0,0] op_sel_hi:[1,1,0]
    v_permlane16_swap_b32 v38, v39
    v_pk_fma_f32 v[46:47], v[46:47], s[68:69], v[36:37] op_sel:[0,0,0] op_sel_hi:[1,1,0]
    v_pk_fma_f32 v[80:81], v[80:81], s[68:69], v[36:37] op_sel:[0,0,1] op_sel_hi:[1,1,1]
    v_pk_fma_f32 v[82:83], v[82:83], s[68:69], v[36:37] op_sel:[0,0,1] op_sel_hi:[1,1,1]
    v_pk_fma_f32 v[68:69], v[68:69], s[68:69], v[38:39] op_sel:[0,0,0] op_sel_hi:[1,1,0]
    v_pk_fma_f32 v[70:71], v[70:71], s[68:69], v[38:39] op_sel:[0,0,0] op_sel_hi:[1,1,0]
    v_pk_fma_f32 v[48:49], v[48:49], s[68:69], v[38:39] op_sel:[0,0,1] op_sel_hi:[1,1,1]
    v_pk_fma_f32 v[50:51], v[50:51], s[68:69], v[38:39] op_sel:[0,0,1] op_sel_hi:[1,1,1]
    v_exp_f32 v44, v44
    v_exp_f32 v45, v45
    v_exp_f32 v46, v46
    v_exp_f32 v47, v47
    v_exp_f32 v80, v80
    v_exp_f32 v81, v81
    v_exp_f32 v82, v82
    v_exp_f32 v83, v83
    v_exp_f32 v68, v68
    v_exp_f32 v69, v69
    v_exp_f32 v70, v70
    v_exp_f32 v71, v71
    v_exp_f32 v48, v48
    v_exp_f32 v49, v49
    v_exp_f32 v50, v50
    v_exp_f32 v51, v51
    v_pk_add_f32 v[84:85], v[44:45], v[46:47]
    v_pk_add_f32 v[72:73], v[80:81], v[82:83]
    v_pk_add_f32 v[52:53], v[68:69], v[70:71]
    v_pk_add_f32 v[88:89], v[48:49], v[50:51]
    v_add_f32 v36, v84, v85
    v_add_f32 v37, v72, v73
    v_add_f32 v38, v52, v53
    v_add_f32 v39, v88, v89
    v_permlane16_swap_b32 v36, v37
    v_add_f32 v36, v36, v37
    v_permlane16_swap_b32 v38, v39
    v_add_f32 v38, v38, v39
    s_nop 1
    v_permlane32_swap_b32 v36, v38
    v_add_f32 v36, v36, v38
    v_rcp_f32 v36, v36
    s_nop 0
    v_mul_f32 v36, v36, v148
    v_mov_b32 v38, v36
    s_nop 1
    v_permlane32_swap_b32 v36, v38
    v_mov_b32 v37, v36
    v_mov_b32 v39, v38
    s_nop 0
    v_permlane16_swap_b32 v36, v37
    v_pk_mul_f32 v[44:45], v[44:45], v[36:37] op_sel:[0,0] op_sel_hi:[1,0]
    v_permlane16_swap_b32 v38, v39
    v_pk_mul_f32 v[46:47], v[46:47], v[36:37] op_sel:[0,0] op_sel_hi:[1,0]
    v_cvt_pk_bf16_f32 v86, v44, v45
    v_cvt_pk_bf16_f32 v87, v46, v47
    v_and_b32 v84, v86, v150
    v_and_b32 v85, v87, v151
    v_xor_b32 v86, v86, v84
    v_xor_b32 v87, v87, v85
    v_pk_mul_f32 v[80:81], v[80:81], v[36:37] op_sel:[0,1] op_sel_hi:[1,1]
    v_pk_mul_f32 v[82:83], v[82:83], v[36:37] op_sel:[0,1] op_sel_hi:[1,1]
    v_mfma_f32_16x16x32_bf16 v[44:47], v[102:105], v[84:87], 0
    v_cvt_pk_bf16_f32 v74, v80, v81
    v_cvt_pk_bf16_f32 v75, v82, v83
    v_mfma_f32_16x16x32_bf16 v[136:139], v[126:129], v[84:87], 0
    v_and_b32 v72, v74, v150
    v_and_b32 v73, v75, v151
    v_xor_b32 v74, v74, v72
    v_xor_b32 v75, v75, v73
    v_pk_mul_f32 v[68:69], v[68:69], v[38:39] op_sel:[0,0] op_sel_hi:[1,0]
    v_pk_mul_f32 v[70:71], v[70:71], v[38:39] op_sel:[0,0] op_sel_hi:[1,0]
    v_mfma_f32_16x16x32_bf16 v[80:83], v[108:111], v[72:75], 0
    v_cvt_pk_bf16_f32 v54, v68, v69
    v_cvt_pk_bf16_f32 v55, v70, v71
    v_mfma_f32_16x16x32_bf16 v[16:19], v[126:129], v[72:75], 0
    v_and_b32 v52, v54, v150
    v_and_b32 v53, v55, v151
    v_xor_b32 v54, v54, v52
    v_xor_b32 v55, v55, v53
    v_pk_mul_f32 v[48:49], v[48:49], v[38:39] op_sel:[0,1] op_sel_hi:[1,1]
    v_pk_mul_f32 v[50:51], v[50:51], v[38:39] op_sel:[0,1] op_sel_hi:[1,1]
    v_mfma_f32_16x16x32_bf16 v[68:71], v[114:117], v[52:55], 0
    v_cvt_pk_bf16_f32 v90, v48, v49
    v_cvt_pk_bf16_f32 v91, v50, v51
    v_mfma_f32_16x16x32_bf16 v[20:23], v[126:129], v[52:55], 0
    v_and_b32 v88, v90, v150
    v_and_b32 v89, v91, v151
    v_xor_b32 v90, v90, v88
    v_xor_b32 v91, v91, v89
    v_cvt_pk_bf16_f32 v84, v44, v45
    v_cvt_pk_bf16_f32 v85, v46, v47
    v_mfma_f32_16x16x32_bf16 v[48:51], v[120:123], v[88:91], 0
    v_cvt_pk_bf16_f32 v86, v80, v81
    v_cvt_pk_bf16_f32 v87, v82, v83
    v_mfma_f32_16x16x32_bf16 v[24:27], v[126:129], v[88:91], 0
    v_add_u32 v74, v84, v85
    v_add3_u32 v74, v86, v87, v74
    v_cvt_pk_bf16_f32 v52, v68, v69
    v_cvt_pk_bf16_f32 v53, v70, v71
    v_add3_u32 v74, v52, v53, v74
    v_cvt_pk_bf16_f32 v54, v48, v49
    v_cvt_pk_bf16_f32 v55, v50, v51
    v_add3_u32 v74, v54, v55, v74
    v_mov_b32_dpp v136, v16 quad_perm:[0,1,2,3] row_mask:0x2 bank_mask:0xf
    v_mov_b32_dpp v137, v17 quad_perm:[0,1,2,3] row_mask:0x2 bank_mask:0xf
    v_mov_b32_dpp v138, v18 quad_perm:[0,1,2,3] row_mask:0x2 bank_mask:0xf
    v_mov_b32_dpp v139, v19 quad_perm:[0,1,2,3] row_mask:0x2 bank_mask:0xf
    v_mov_b32_dpp v136, v20 quad_perm:[0,1,2,3] row_mask:0x4 bank_mask:0xf
    v_mov_b32_dpp v137, v21 quad_perm:[0,1,2,3] row_mask:0x4 bank_mask:0xf
    v_mov_b32_dpp v138, v22 quad_perm:[0,1,2,3] row_mask:0x4 bank_mask:0xf
    v_mov_b32_dpp v139, v23 quad_perm:[0,1,2,3] row_mask:0x4 bank_mask:0xf
    v_mov_b32_dpp v136, v24 quad_perm:[0,1,2,3] row_mask:0x8 bank_mask:0xf
    v_mov_b32_dpp v137, v25 quad_perm:[0,1,2,3] row_mask:0x8 bank_mask:0xf
    v_mov_b32_dpp v138, v26 quad_perm:[0,1,2,3] row_mask:0x8 bank_mask:0xf
    v_mov_b32_dpp v139, v27 quad_perm:[0,1,2,3] row_mask:0x8 bank_mask:0xf
    v_cvt_pk_bf16_f32 v72, v136, v137
    v_cvt_pk_bf16_f32 v73, v138, v139
    v_add3_u32 v89, v72, v73, v74
    v_permlane32_swap_b32 v72, v74
    v_permlane32_swap_b32 v73, v75
    v_mov_b32 v88, s10
    v_add_u32_dpp v89, v89, v89 row_shr:1 row_mask:0xf bank_mask:0xf bound_ctrl:0
    s_nop 1
    v_add_u32_dpp v89, v89, v89 row_shr:2 row_mask:0xf bank_mask:0xf bound_ctrl:0
    s_nop 1
    v_add_u32_dpp v89, v89, v89 row_shr:4 row_mask:0xf bank_mask:0xf bound_ctrl:0
    s_nop 1
    v_add_u32_dpp v89, v89, v89 row_shr:8 row_mask:0xf bank_mask:0xf bound_ctrl:0
    s_nop 1
    v_add_u32_dpp v89, v89, v89 row_bcast:15 row_mask:0xa bank_mask:0xf
    s_nop 1
    v_add_u32_dpp v89, v89, v89 row_bcast:31 row_mask:0xc bank_mask:0xf
    s_barrier
    buffer_store_dwordx4 v[72:75], v0, s[40:43], s100 offen offset:2048 sc1
    buffer_store_dwordx4 v[84:87], v4, s[40:43], s100 offen offset:0 sc1
    buffer_store_dwordx4 v[52:55], v4, s[40:43], s100 offen offset:1024 sc1
    buffer_store_dwordx2 v[88:89], v5, s[40:43], s56 offen offset:0 sc1
    s_nop 0
    s_nop 0
    v_lshlrev_b32 v2, 4, v1
    v_add_u32 v3, 81920, v2
    v_subrev_u32 v111, 40960, v14
    v_and_b32 v4, 0x1f0, v2
    v_lshrrev_b32 v5, 5, v1
    v_lshl_add_u32 v4, v5, 3, v4
    v_add_u32 v5, 81920, v4
    v_bfe_u32 v8, v1, 3, 2
    v_bfe_u32 v9, v1, 1, 2
    v_lshl_add_u32 v8, v9, 2, v8
    v_mul_u32_u24 v8, 2560, v8
    v_and_b32 v9, 1, v1
    v_lshl_add_u32 v8, v9, 4, v8
    v_lshrrev_b32 v9, 5, v1
    v_mad_u32_u24 v12, v9, s9, v8
    v_mad_u32_u24 v13, v9, s59, v8
    v_lshl_add_u32 v10, v1, 5, s54
    v_lshl_add_u32 v11, v1, 5, s57
    s_mov_b32 s44, s18
    s_and_b32 s45, s19, 0xffff
    s_mov_b32 s46, 2621440
    s_mov_b32 s47, 0x20000
L_ph2:
    s_mov_b32 s67, 0
L_pl:
    s_load_dwordx16 s[24:39], s[22:23], s49 glc
L_pw:
    s_add_u32 s67, s67, 1
    s_waitcnt lgkmcnt(0)
    s_xor_b32 s24, s24, s11
    s_xor_b32 s26, s26, s11
    s_xor_b32 s28, s28, s11
    s_xor_b32 s30, s30, s11
    s_xor_b32 s32, s32, s11
    s_xor_b32 s34, s34, s11
    s_xor_b32 s36, s36, s11
    s_xor_b32 s38, s38, s11
    s_or_b32 s24, s24, s26
    s_or_b32 s24, s24, s28
    s_or_b32 s24, s24, s30
    s_or_b32 s24, s24, s32
    s_or_b32 s24, s24, s34
    s_or_b32 s24, s24, s36
    s_or_b32 s24, s24, s38
    s_cbranch_scc0 L_pd
    s_cmp_lt_u32 s67, 0x100000
    s_cbranch_scc1 L_pl
L_pd:
    buffer_load_dwordx4 v[16:19], v2, s[40:43], s50 offen offset:0 sc1
    buffer_load_dwordx4 v[20:23], v3, s[40:43], s50 offen offset:0 sc1
    buffer_load_dwordx4 v[24:27], v2, s[40:43], s50 offen offset:1024 sc1
    buffer_load_dwordx4 v[28:31], v3, s[40:43], s50 offen offset:1024 sc1
    buffer_load_dwordx2 v[48:49], v4, s[40:43], s50 offen offset:2048 sc1
    buffer_load_dwordx2 v[52:53], v5, s[40:43], s50 offen offset:2048 sc1
    buffer_load_dwordx4 v[32:35], v2, s[40:43], s51 offen offset:0 sc1
    buffer_load_dwordx4 v[36:39], v3, s[40:43], s51 offen offset:0 sc1
    buffer_load_dwordx4 v[40:43], v2, s[40:43], s51 offen offset:1024 sc1
    buffer_load_dwordx4 v[44:47], v3, s[40:43], s51 offen offset:1024 sc1
    buffer_load_dwordx2 v[50:51], v4, s[40:43], s51 offen offset:2048 sc1
    buffer_load_dwordx2 v[54:55], v5, s[40:43], s51 offen offset:2048 sc1
    buffer_load_dwordx4 v[56:59], v2, s[40:43], s52 offen offset:0 sc1
    buffer_load_dwordx4 v[60:63], v3, s[40:43], s52 offen offset:0 sc1
    buffer_load_dwordx4 v[64:67], v2, s[40:43], s52 offen offset:1024 sc1
    buffer_load_dwordx4 v[68:71], v3, s[40:43], s52 offen offset:1024 sc1
    buffer_load_dwordx2 v[88:89], v4, s[40:43], s52 offen offset:2048 sc1
    buffer_load_dwordx2 v[92:93], v5, s[40:43], s52 offen offset:2048 sc1
    s_cmp_lt_u32 s60, 4
    s_cbranch_scc1 L_nw2
    s_barrier
L_nw2:
    buffer_load_dwordx4 v[72:75], v2, s[40:43], s53 offen offset:0 sc1
    buffer_load_dwordx4 v[76:79], v3, s[40:43], s53 offen offset:0 sc1
    buffer_load_dwordx4 v[80:83], v2, s[40:43], s53 offen offset:1024 sc1
    buffer_load_dwordx4 v[84:87], v3, s[40:43], s53 offen offset:1024 sc1
    buffer_load_dwordx2 v[90:91], v4, s[40:43], s53 offen offset:2048 sc1
    buffer_load_dwordx2 v[94:95], v5, s[40:43], s53 offen offset:2048 sc1
    s_and_b32 s66, s60, 3
    s_mul_i32 m0, s66, 10240
    s_waitcnt vmcnt(22)
L_rt0:
    v_mfma_f32_16x16x32_bf16 v[112:115], v[16:19], a[44:47], 0
    s_waitcnt vmcnt(18)
    v_add3_u32 v8, v16, v17, v18
    v_add3_u32 v9, v19, v20, v21
    v_add3_u32 v8, v8, v22, v23
    v_mfma_f32_16x16x32_bf16 v[132:135], v[20:23], a[44:47], 0
    v_add3_u32 v9, v9, v24, v25
    v_add3_u32 v8, v8, v26, v27
    v_add3_u32 v9, v9, v28, v29
    v_add3_u32 v8, v8, v30, v31
    v_mfma_f32_16x16x32_bf16 v[116:119], v[16:19], a[48:51], 0
    v_add3_u32 v9, v9, v48, v49
    v_add3_u32 v8, v8, v52, v53
    v_add_u32 v8, v8, v9
    v_mfma_f32_16x16x32_bf16 v[136:139], v[20:23], a[48:51], 0
    s_nop 0
    v_add_u32_dpp v8, v8, v8 row_shr:1 row_mask:0xf bank_mask:0xf bound_ctrl:0
    v_mfma_f32_16x16x32_bf16 v[120:123], v[16:19], a[52:55], 0
    s_nop 0
    v_add_u32_dpp v8, v8, v8 row_shr:2 row_mask:0xf bank_mask:0xf bound_ctrl:0
    v_mfma_f32_16x16x32_bf16 v[140:143], v[20:23], a[52:55], 0
    s_nop 0
    v_add_u32_dpp v8, v8, v8 row_shr:4 row_mask:0xf bank_mask:0xf bound_ctrl:0
    v_mfma_f32_16x16x32_bf16 v[124:127], v[16:19], a[56:59], 0
    s_nop 0
    v_add_u32_dpp v8, v8, v8 row_shr:8 row_mask:0xf bank_mask:0xf bound_ctrl:0
    v_mfma_f32_16x16x32_bf16 v[144:147], v[20:23], a[56:59], 0
    s_nop 0
    v_add_u32_dpp v8, v8, v8 row_bcast:15 row_mask:0xa bank_mask:0xf
    v_mfma_f32_16x16x32_bf16 v[128:131], v[16:19], a[76:79], 0
    s_nop 0
    v_add_u32_dpp v8, v8, v8 row_bcast:31 row_mask:0xc bank_mask:0xf
    v_mfma_f32_16x16x32_bf16 v[148:151], v[20:23], a[76:79], 0
    v_readlane_b32 s66, v8, 63
    s_add_u32 s3, s25, s33
    s_cmp_lg_u32 s66, s3
    s_cbranch_scc1 L_sl0
L_gv0:
    v_mfma_f32_16x16x32_bf16 v[112:115], v[24:27], a[80:83], v[112:115]
    s_waitcnt vmcnt(12)
    v_add3_u32 v8, v32, v33, v34
    v_add3_u32 v9, v35, v36, v37
    v_add3_u32 v8, v8, v38, v39
    v_mfma_f32_16x16x32_bf16 v[132:135], v[28:31], a[80:83], v[132:135]
    v_add3_u32 v9, v9, v40, v41
    v_add3_u32 v8, v8, v42, v43
    v_add3_u32 v9, v9, v44, v45
    v_add3_u32 v8, v8, v46, v47
    v_mfma_f32_16x16x32_bf16 v[116:119], v[24:27], a[84:87], v[116:119]
    v_add3_u32 v9, v9, v50, v51
    v_add3_u32 v8, v8, v54, v55
    v_add_u32 v8, v8, v9
    v_mfma_f32_16x16x32_bf16 v[136:139], v[28:31], a[84:87], v[136:139]
    ds_read_b128 a[44:47], v111 offset:0
    v_add_u32_dpp v8, v8, v8 row_shr:1 row_mask:0xf bank_mask:0xf bound_ctrl:0
    v_mfma_f32_16x16x32_bf16 v[120:123], v[24:27], a[96:99], v[120:123]
    ds_read_b128 a[48:51], v111 offset:4096
    v_add_u32_dpp v8, v8, v8 row_shr:2 row_mask:0xf bank_mask:0xf bound_ctrl:0
    v_mfma_f32_16x16x32_bf16 v[140:143], v[28:31], a[96:99], v[140:143]
    ds_read_b128 a[52:55], v111 offset:8192
    v_add_u32_dpp v8, v8, v8 row_shr:4 row_mask:0xf bank_mask:0xf bound_ctrl:0
    v_mfma_f32_16x16x32_bf16 v[124:127], v[24:27], a[100:103], v[124:127]
    ds_read_b128 a[56:59], v111 offset:12288
    v_add_u32_dpp v8, v8, v8 row_shr:8 row_mask:0xf bank_mask:0xf bound_ctrl:0
    v_mfma_f32_16x16x32_bf16 v[144:147], v[28:31], a[100:103], v[144:147]
    ds_read_b128 a[76:79], v111 offset:16384
    v_add_u32_dpp v8, v8, v8 row_bcast:15 row_mask:0xa bank_mask:0xf
    v_mfma_f32_16x16x32_bf16 v[128:131], v[24:27], a[20:23], v[128:131]
    s_nop 0
    v_add_u32_dpp v8, v8, v8 row_bcast:31 row_mask:0xc bank_mask:0xf
    v_mfma_f32_16x16x32_bf16 v[148:151], v[28:31], a[20:23], v[148:151]
    v_readlane_b32 s66, v8, 63
    s_add_u32 s3, s27, s35
    s_cmp_lg_u32 s66, s3
    s_cbranch_scc1 L_sl1
L_rt1:
    v_mfma_f32_16x16x32_bf16 v[112:115], v[32:35], a[24:27], v[112:115]
    ds_read_b128 a[80:83], v111 offset:20480
    ds_read_b128 a[84:87], v111 offset:24576
    v_mfma_f32_16x16x32_bf16 v[132:135], v[36:39], a[24:27], v[132:135]
    ds_read_b128 a[96:99], v111 offset:28672
    ds_read_b128 a[100:103], v111 offset:32768
    v_mfma_f32_16x16x32_bf16 v[116:119], v[32:35], a[28:31], v[116:119]
    ds_read_b128 a[20:23], v111 offset:36864
    v_mfma_f32_16x16x32_bf16 v[136:139], v[36:39], a[28:31], v[136:139]
    v_mfma_f32_16x16x32_bf16 v[120:123], v[32:35], a[32:35], v[120:123]
    v_mfma_f32_16x16x32_bf16 v[140:143], v[36:39], a[32:35], v[140:143]
    v_mfma_f32_16x16x32_bf16 v[124:127], v[32:35], a[36:39], v[124:127]
    v_mfma_f32_16x16x32_bf16 v[144:147], v[36:39], a[36:39], v[144:147]
    v_mfma_f32_16x16x32_bf16 v[128:131], v[32:35], a[0:3], v[128:131]
    v_mfma_f32_16x16x32_bf16 v[148:151], v[36:39], a[0:3], v[148:151]
    v_mfma_f32_16x16x32_bf16 v[112:115], v[40:43], a[4:7], v[112:115]
    ds_read_b128 a[24:27], v14 offset:0
    ds_read_b128 a[28:31], v14 offset:4096
    v_mfma_f32_16x16x32_bf16 v[132:135], v[44:47], a[4:7], v[132:135]
    ds_read_b128 a[32:35], v14 offset:8192
    ds_read_b128 a[36:39], v14 offset:12288
    v_mfma_f32_16x16x32_bf16 v[116:119], v[40:43], a[8:11], v[116:119]
    ds_read_b128 a[0:3], v14 offset:16384
    v_mfma_f32_16x16x32_bf16 v[136:139], v[44:47], a[8:11], v[136:139]
    v_mfma_f32_16x16x32_bf16 v[120:123], v[40:43], a[12:15], v[120:123]
    v_mfma_f32_16x16x32_bf16 v[140:143], v[44:47], a[12:15], v[140:143]
    v_mfma_f32_16x16x32_bf16 v[124:127], v[40:43], a[16:19], v[124:127]
    v_mfma_f32_16x16x32_bf16 v[144:147], v[44:47], a[16:19], v[144:147]
    v_mfma_f32_16x16x32_bf16 v[128:131], v[40:43], a[40:43], v[128:131]
    v_mfma_f32_16x16x32_bf16 v[148:151], v[44:47], a[40:43], v[148:151]
    v_mfma_f32_16x16x32_bf16 v[112:115], v[48:51], a[60:63], v[112:115]
    s_waitcnt vmcnt(6)
    v_add3_u32 v8, v56, v57, v58
    v_add3_u32 v9, v59, v60, v61
    v_add3_u32 v8, v8, v62, v63
    v_mfma_f32_16x16x32_bf16 v[132:135], v[52:55], a[60:63], v[132:135]
    v_add3_u32 v9, v9, v64, v65
    v_add3_u32 v8, v8, v66, v67
    v_add3_u32 v9, v9, v68, v69
    v_add3_u32 v8, v8, v70, v71
    v_mfma_f32_16x16x32_bf16 v[116:119], v[48:51], a[64:67], v[116:119]
    v_add3_u32 v9, v9, v88, v89
    v_add3_u32 v8, v8, v92, v93
    v_add_u32 v8, v8, v9
    v_mfma_f32_16x16x32_bf16 v[136:139], v[52:55], a[64:67], v[136:139]
    ds_read_b128 a[4:7], v14 offset:20480
    v_add_u32_dpp v8, v8, v8 row_shr:1 row_mask:0xf bank_mask:0xf bound_ctrl:0
    v_mfma_f32_16x16x32_bf16 v[120:123], v[48:51], a[68:71], v[120:123]
    ds_read_b128 a[8:11], v14 offset:24576
    v_add_u32_dpp v8, v8, v8 row_shr:2 row_mask:0xf bank_mask:0xf bound_ctrl:0
    v_mfma_f32_16x16x32_bf16 v[140:143], v[52:55], a[68:71], v[140:143]
    ds_read_b128 a[12:15], v14 offset:28672
    v_add_u32_dpp v8, v8, v8 row_shr:4 row_mask:0xf bank_mask:0xf bound_ctrl:0
    v_mfma_f32_16x16x32_bf16 v[124:127], v[48:51], a[72:75], v[124:127]
    ds_read_b128 a[16:19], v14 offset:32768
    v_add_u32_dpp v8, v8, v8 row_shr:8 row_mask:0xf bank_mask:0xf bound_ctrl:0
    v_mfma_f32_16x16x32_bf16 v[144:147], v[52:55], a[72:75], v[144:147]
    ds_read_b128 a[40:43], v14 offset:36864
    v_add_u32_dpp v8, v8, v8 row_bcast:15 row_mask:0xa bank_mask:0xf
    v_mfma_f32_16x16x32_bf16 v[128:131], v[48:51], a[88:91], v[128:131]
    s_nop 0
    v_add_u32_dpp v8, v8, v8 row_bcast:31 row_mask:0xc bank_mask:0xf
    v_mfma_f32_16x16x32_bf16 v[148:151], v[52:55], a[88:91], v[148:151]
    v_readlane_b32 s66, v8, 63
    s_add_u32 s3, s29, s37
    s_cmp_lg_u32 s66, s3
    s_cbranch_scc1 L_sl2
L_rt2:
    s_waitcnt lgkmcnt(0)
    v_mfma_f32_16x16x32_bf16 v[112:115], v[56:59], a[44:47], v[112:115]
    ds_read_b128 a[60:63], v14 offset:40960
    ds_read_b128 a[64:67], v14 offset:45056
    v_mfma_f32_16x16x32_bf16 v[132:135], v[60:63], a[44:47], v[132:135]
    ds_read_b128 a[68:71], v14 offset:49152
    ds_read_b128 a[72:75], v14 offset:53248
    v_mfma_f32_16x16x32_bf16 v[116:119], v[56:59], a[48:51], v[116:119]
    ds_read_b128 a[88:91], v14 offset:57344
    v_mfma_f32_16x16x32_bf16 v[136:139], v[60:63], a[48:51], v[136:139]
    v_mfma_f32_16x16x32_bf16 v[120:123], v[56:59], a[52:55], v[120:123]
    v_mfma_f32_16x16x32_bf16 v[140:143], v[60:63], a[52:55], v[140:143]
    v_mfma_f32_16x16x32_bf16 v[124:127], v[56:59], a[56:59], v[124:127]
    v_mfma_f32_16x16x32_bf16 v[144:147], v[60:63], a[56:59], v[144:147]
    v_mfma_f32_16x16x32_bf16 v[128:131], v[56:59], a[76:79], v[128:131]
    v_mfma_f32_16x16x32_bf16 v[148:151], v[60:63], a[76:79], v[148:151]
    v_mfma_f32_16x16x32_bf16 v[112:115], v[64:67], a[80:83], v[112:115]
    s_waitcnt vmcnt(0)
    v_add3_u32 v8, v72, v73, v74
    v_add3_u32 v9, v75, v76, v77
    v_add3_u32 v8, v8, v78, v79
    v_mfma_f32_16x16x32_bf16 v[132:135], v[68:71], a[80:83], v[132:135]
    v_add3_u32 v9, v9, v80, v81
    v_add3_u32 v8, v8, v82, v83
    v_add3_u32 v9, v9, v84, v85
    v_add3_u32 v8, v8, v86, v87
    v_mfma_f32_16x16x32_bf16 v[116:119], v[64:67], a[84:87], v[116:119]
    v_add3_u32 v9, v9, v90, v91
    v_add3_u32 v8, v8, v94, v95
    v_add_u32 v8, v8, v9
    v_mfma_f32_16x16x32_bf16 v[136:139], v[68:71], a[84:87], v[136:139]
    s_nop 0
    v_add_u32_dpp v8, v8, v8 row_shr:1 row_mask:0xf bank_mask:0xf bound_ctrl:0
    v_mfma_f32_16x16x32_bf16 v[120:123], v[64:67], a[96:99], v[120:123]
    s_nop 0
    v_add_u32_dpp v8, v8, v8 row_shr:2 row_mask:0xf bank_mask:0xf bound_ctrl:0
    v_mfma_f32_16x16x32_bf16 v[140:143], v[68:71], a[96:99], v[140:143]
    s_nop 0
    v_add_u32_dpp v8, v8, v8 row_shr:4 row_mask:0xf bank_mask:0xf bound_ctrl:0
    v_mfma_f32_16x16x32_bf16 v[124:127], v[64:67], a[100:103], v[124:127]
    s_nop 0
    v_add_u32_dpp v8, v8, v8 row_shr:8 row_mask:0xf bank_mask:0xf bound_ctrl:0
    v_mfma_f32_16x16x32_bf16 v[144:147], v[68:71], a[100:103], v[144:147]
    s_nop 0
    v_add_u32_dpp v8, v8, v8 row_bcast:15 row_mask:0xa bank_mask:0xf
    v_mfma_f32_16x16x32_bf16 v[128:131], v[64:67], a[20:23], v[128:131]
    s_nop 0
    v_add_u32_dpp v8, v8, v8 row_bcast:31 row_mask:0xc bank_mask:0xf
    v_mfma_f32_16x16x32_bf16 v[148:151], v[68:71], a[20:23], v[148:151]
    v_readlane_b32 s66, v8, 63
    s_add_u32 s3, s31, s39
    s_cmp_lg_u32 s66, s3
    s_cbranch_scc1 L_sl3
L_rt3:
    s_cmp_ge_u32 s60, 4
    s_cbranch_scc1 L_np1
    s_barrier
L_np1:
    v_mfma_f32_16x16x32_bf16 v[112:115], v[72:75], a[24:27], v[112:115]
    v_mfma_f32_16x16x32_bf16 v[132:135], v[76:79], a[24:27], v[132:135]
    v_mfma_f32_16x16x32_bf16 v[116:119], v[72:75], a[28:31], v[116:119]
    v_mfma_f32_16x16x32_bf16 v[136:139], v[76:79], a[28:31], v[136:139]
    v_mfma_f32_16x16x32_bf16 v[120:123], v[72:75], a[32:35], v[120:123]
    v_mfma_f32_16x16x32_bf16 v[140:143], v[76:79], a[32:35], v[140:143]
    v_mfma_f32_16x16x32_bf16 v[124:127], v[72:75], a[36:39], v[124:127]
    v_mfma_f32_16x16x32_bf16 v[144:147], v[76:79], a[36:39], v[144:147]
    v_mfma_f32_16x16x32_bf16 v[128:131], v[72:75], a[0:3], v[128:131]
    v_mfma_f32_16x16x32_bf16 v[148:151], v[76:79], a[0:3], v[148:151]
    v_mfma_f32_16x16x32_bf16 v[112:115], v[80:83], a[4:7], v[112:115]
    v_mfma_f32_16x16x32_bf16 v[132:135], v[84:87], a[4:7], v[132:135]
    v_mfma_f32_16x16x32_bf16 v[116:119], v[80:83], a[8:11], v[116:119]
    v_mfma_f32_16x16x32_bf16 v[136:139], v[84:87], a[8:11], v[136:139]
    v_mfma_f32_16x16x32_bf16 v[120:123], v[80:83], a[12:15], v[120:123]
    v_mfma_f32_16x16x32_bf16 v[140:143], v[84:87], a[12:15], v[140:143]
    v_mfma_f32_16x16x32_bf16 v[124:127], v[80:83], a[16:19], v[124:127]
    v_mfma_f32_16x16x32_bf16 v[144:147], v[84:87], a[16:19], v[144:147]
    v_mfma_f32_16x16x32_bf16 v[128:131], v[80:83], a[40:43], v[128:131]
    v_mfma_f32_16x16x32_bf16 v[148:151], v[84:87], a[40:43], v[148:151]
    s_waitcnt lgkmcnt(0)
    v_mfma_f32_16x16x32_bf16 v[112:115], v[88:91], a[60:63], v[112:115]
    s_cmp_lt_u32 s60, 4
    v_mfma_f32_16x16x32_bf16 v[132:135], v[92:95], a[60:63], v[132:135]
    v_mfma_f32_16x16x32_bf16 v[116:119], v[88:91], a[64:67], v[116:119]
    v_mfma_f32_16x16x32_bf16 v[136:139], v[92:95], a[64:67], v[136:139]
    v_mfma_f32_16x16x32_bf16 v[120:123], v[88:91], a[68:71], v[120:123]
    v_mfma_f32_16x16x32_bf16 v[140:143], v[92:95], a[68:71], v[140:143]
    v_mfma_f32_16x16x32_bf16 v[124:127], v[88:91], a[72:75], v[124:127]
    v_mfma_f32_16x16x32_bf16 v[144:147], v[92:95], a[72:75], v[144:147]
    v_mfma_f32_16x16x32_bf16 v[128:131], v[88:91], a[88:91], v[128:131]
    v_mfma_f32_16x16x32_bf16 v[148:151], v[92:95], a[88:91], v[148:151]
    s_cbranch_scc1 L_late
    s_add_u32 s66, m0, 122880
    v_lshl_add_u32 v4, v1, 2, s66
    ds_write2st64_b32 v4, v112, v113 offset0:0 offset1:1
    ds_write2st64_b32 v4, v114, v115 offset0:2 offset1:3
    ds_write2st64_b32 v4, v132, v133 offset0:20 offset1:21
    ds_write2st64_b32 v4, v134, v135 offset0:22 offset1:23
    ds_write2st64_b32 v4, v116, v117 offset0:4 offset1:5
    ds_write2st64_b32 v4, v118, v119 offset0:6 offset1:7
    ds_write2st64_b32 v4, v136, v137 offset0:24 offset1:25
    ds_write2st64_b32 v4, v138, v139 offset0:26 offset1:27
    ds_write2st64_b32 v4, v120, v121 offset0:8 offset1:9
    ds_write2st64_b32 v4, v122, v123 offset0:10 offset1:11
    ds_write2st64_b32 v4, v140, v141 offset0:28 offset1:29
    ds_write2st64_b32 v4, v142, v143 offset0:30 offset1:31
    ds_write2st64_b32 v4, v124, v125 offset0:12 offset1:13
    ds_write2st64_b32 v4, v126, v127 offset0:14 offset1:15
    ds_write2st64_b32 v4, v144, v145 offset0:32 offset1:33
    ds_write2st64_b32 v4, v146, v147 offset0:34 offset1:35
    ds_write2st64_b32 v4, v128, v129 offset0:16 offset1:17
    ds_write2st64_b32 v4, v130, v131 offset0:18 offset1:19
    ds_write2st64_b32 v4, v148, v149 offset0:36 offset1:37
    ds_write2st64_b32 v4, v150, v151 offset0:38 offset1:39
    s_waitcnt lgkmcnt(0)
    s_barrier
    ds_read_b128 v[48:51], v10 offset:0
    ds_read_b128 v[52:55], v10 offset:16
    ds_read_b128 v[56:59], v10 offset:10240
    ds_read_b128 v[60:63], v10 offset:10256
    ds_read_b128 v[64:67], v10 offset:20480
    ds_read_b128 v[68:71], v10 offset:20496
    ds_read_b128 v[72:75], v10 offset:30720
    ds_read_b128 v[76:79], v10 offset:30736
    s_waitcnt lgkmcnt(4)
    v_pk_add_f32 v[48:49], v[48:49], v[56:57]
    v_pk_add_f32 v[50:51], v[50:51], v[58:59]
    v_pk_add_f32 v[52:53], v[52:53], v[60:61]
    v_pk_add_f32 v[54:55], v[54:55], v[62:63]
    s_waitcnt lgkmcnt(0)
    v_pk_add_f32 v[64:65], v[64:65], v[72:73]
    v_pk_add_f32 v[66:67], v[66:67], v[74:75]
    v_pk_add_f32 v[68:69], v[68:69], v[76:77]
    v_pk_add_f32 v[70:71], v[70:71], v[78:79]
    v_pk_add_f32 v[48:49], v[48:49], v[64:65]
    v_pk_add_f32 v[50:51], v[50:51], v[66:67]
    v_pk_add_f32 v[52:53], v[52:53], v[68:69]
    v_pk_add_f32 v[54:55], v[54:55], v[70:71]
    v_cvt_pk_bf16_f32 v56, v48, v49
    v_cvt_pk_bf16_f32 v57, v50, v51
    v_cvt_pk_bf16_f32 v58, v52, v53
    v_cvt_pk_bf16_f32 v59, v54, v55
    buffer_store_dwordx4 v[56:59], v12, s[44:47], s55 offen
    s_cmp_ge_u32 s60, 6
    s_barrier
    s_cbranch_scc1 L_fin
    ds_read_b128 v[16:19], v11 offset:0
    ds_read_b128 v[20:23], v11 offset:16
    ds_read_b128 v[24:27], v11 offset:10240
    ds_read_b128 v[28:31], v11 offset:10256
    ds_read_b128 v[32:35], v11 offset:20480
    ds_read_b128 v[36:39], v11 offset:20496
    ds_read_b128 v[40:43], v11 offset:30720
    ds_read_b128 v[44:47], v11 offset:30736
    s_branch L_red
L_late:
    ds_write_addtid_b32 v112 offset:0
    ds_write_addtid_b32 v113 offset:256
    ds_write_addtid_b32 v114 offset:512
    ds_write_addtid_b32 v115 offset:768
    ds_write_addtid_b32 v132 offset:5120
    ds_write_addtid_b32 v133 offset:5376
    ds_write_addtid_b32 v134 offset:5632
    ds_write_addtid_b32 v135 offset:5888
    ds_write_addtid_b32 v116 offset:1024
    ds_write_addtid_b32 v117 offset:1280
    ds_write_addtid_b32 v118 offset:1536
    ds_write_addtid_b32 v119 offset:1792
    ds_write_addtid_b32 v136 offset:6144
    ds_write_addtid_b32 v137 offset:6400
    ds_write_addtid_b32 v138 offset:6656
    ds_write_addtid_b32 v139 offset:6912
    ds_write_addtid_b32 v120 offset:2048
    ds_write_addtid_b32 v121 offset:2304
    ds_write_addtid_b32 v122 offset:2560
    ds_write_addtid_b32 v123 offset:2816
    ds_write_addtid_b32 v140 offset:7168
    ds_write_addtid_b32 v141 offset:7424
    ds_write_addtid_b32 v142 offset:7680
    ds_write_addtid_b32 v143 offset:7936
    ds_write_addtid_b32 v124 offset:3072
    ds_write_addtid_b32 v125 offset:3328
    ds_write_addtid_b32 v126 offset:3584
    ds_write_addtid_b32 v127 offset:3840
    ds_write_addtid_b32 v144 offset:8192
    ds_write_addtid_b32 v145 offset:8448
    ds_write_addtid_b32 v146 offset:8704
    ds_write_addtid_b32 v147 offset:8960
    ds_write_addtid_b32 v128 offset:4096
    ds_write_addtid_b32 v129 offset:4352
    ds_write_addtid_b32 v130 offset:4608
    ds_write_addtid_b32 v131 offset:4864
    ds_write_addtid_b32 v148 offset:9216
    ds_write_addtid_b32 v149 offset:9472
    ds_write_addtid_b32 v150 offset:9728
    ds_write_addtid_b32 v151 offset:9984
    s_waitcnt lgkmcnt(0)
    s_barrier
    ds_read_b128 v[16:19], v11 offset:0
    ds_read_b128 v[20:23], v11 offset:16
    ds_read_b128 v[24:27], v11 offset:10240
    ds_read_b128 v[28:31], v11 offset:10256
    ds_read_b128 v[32:35], v11 offset:20480
    ds_read_b128 v[36:39], v11 offset:20496
    ds_read_b128 v[40:43], v11 offset:30720
    ds_read_b128 v[44:47], v11 offset:30736
L_red:
    s_waitcnt lgkmcnt(4)
    v_pk_add_f32 v[16:17], v[16:17], v[24:25]
    v_pk_add_f32 v[18:19], v[18:19], v[26:27]
    v_pk_add_f32 v[20:21], v[20:21], v[28:29]
    v_pk_add_f32 v[22:23], v[22:23], v[30:31]
    s_waitcnt lgkmcnt(0)
    v_pk_add_f32 v[32:33], v[32:33], v[40:41]
    v_pk_add_f32 v[34:35], v[34:35], v[42:43]
    v_pk_add_f32 v[36:37], v[36:37], v[44:45]
    v_pk_add_f32 v[38:39], v[38:39], v[46:47]
    v_pk_add_f32 v[16:17], v[16:17], v[32:33]
    v_pk_add_f32 v[18:19], v[18:19], v[34:35]
    v_pk_add_f32 v[20:21], v[20:21], v[36:37]
    v_pk_add_f32 v[22:23], v[22:23], v[38:39]
    v_cvt_pk_bf16_f32 v24, v16, v17
    v_cvt_pk_bf16_f32 v25, v18, v19
    v_cvt_pk_bf16_f32 v26, v20, v21
    v_cvt_pk_bf16_f32 v27, v22, v23
    buffer_store_dwordx4 v[24:27], v13, s[44:47], s58 offen
L_fin:
    s_lshl_b32 s66, s62, 3
    s_or_b32 s66, s66, s60
    s_cmp_lg_u32 s66, 7
    s_cbranch_scc1 L_fin2
    s_lshl_b32 s66, s64, 7
    s_add_u32 s66, s66, 6356992
    v_mov_b32 v8, s10
    v_mov_b32 v9, 0
    s_mov_b64 exec, 1
    buffer_store_dword v8, v9, s[40:43], s66 offen
    s_mov_b64 exec, -1
L_fin2:
    s_endpgm
L_sl0:
    s_mov_b32 s67, 0
L_sm0:
    s_load_dwordx16 s[24:39], s[22:23], s49 glc
    s_waitcnt lgkmcnt(0)
    buffer_load_dwordx4 v[16:19], v2, s[40:43], s50 offen offset:0 sc1
    buffer_load_dwordx4 v[20:23], v3, s[40:43], s50 offen offset:0 sc1
    buffer_load_dwordx4 v[24:27], v2, s[40:43], s50 offen offset:1024 sc1
    buffer_load_dwordx4 v[28:31], v3, s[40:43], s50 offen offset:1024 sc1
    buffer_load_dwordx2 v[48:49], v4, s[40:43], s50 offen offset:2048 sc1
    buffer_load_dwordx2 v[52:53], v5, s[40:43], s50 offen offset:2048 sc1
    s_add_u32 s67, s67, 1
    s_waitcnt vmcnt(0)
    v_add3_u32 v8, v16, v17, v18
    v_add3_u32 v9, v19, v20, v21
    v_add3_u32 v8, v8, v22, v23
    v_add3_u32 v9, v9, v24, v25
    v_add3_u32 v8, v8, v26, v27
    v_add3_u32 v9, v9, v28, v29
    v_add3_u32 v8, v8, v30, v31
    v_add3_u32 v9, v9, v48, v49
    v_add3_u32 v8, v8, v52, v53
    v_add_u32 v8, v8, v9
    s_nop 1
    v_add_u32_dpp v8, v8, v8 row_shr:1 row_mask:0xf bank_mask:0xf bound_ctrl:0
    s_nop 1
    v_add_u32_dpp v8, v8, v8 row_shr:2 row_mask:0xf bank_mask:0xf bound_ctrl:0
    s_nop 1
    v_add_u32_dpp v8, v8, v8 row_shr:4 row_mask:0xf bank_mask:0xf bound_ctrl:0
    s_nop 1
    v_add_u32_dpp v8, v8, v8 row_shr:8 row_mask:0xf bank_mask:0xf bound_ctrl:0
    s_nop 1
    v_add_u32_dpp v8, v8, v8 row_bcast:15 row_mask:0xa bank_mask:0xf
    s_nop 1
    v_add_u32_dpp v8, v8, v8 row_bcast:31 row_mask:0xc bank_mask:0xf
    s_nop 0
    v_readlane_b32 s66, v8, 63
    s_add_u32 s3, s25, s33
    s_cmp_lg_u32 s66, s3
    s_cselect_b32 s66, 1, 0
    s_xor_b32 s3, s24, s11
    s_or_b32 s66, s66, s3
    s_xor_b32 s3, s26, s11
    s_or_b32 s66, s66, s3
    s_xor_b32 s3, s28, s11
    s_or_b32 s66, s66, s3
    s_xor_b32 s3, s30, s11
    s_or_b32 s66, s66, s3
    s_xor_b32 s3, s32, s11
    s_or_b32 s66, s66, s3
    s_xor_b32 s3, s34, s11
    s_or_b32 s66, s66, s3
    s_xor_b32 s3, s36, s11
    s_or_b32 s66, s66, s3
    s_xor_b32 s3, s38, s11
    s_or_b32 s66, s66, s3
    s_cbranch_scc0 L_rt0
    s_cmp_lt_u32 s67, 0x40000
    s_cbranch_scc1 L_sm0
    s_branch L_gv0
L_sl1:
    s_mov_b32 s67, 0
L_sm1:
    s_load_dwordx16 s[24:39], s[22:23], s49 glc
    s_waitcnt lgkmcnt(0)
    buffer_load_dwordx4 v[32:35], v2, s[40:43], s51 offen offset:0 sc1
    buffer_load_dwordx4 v[36:39], v3, s[40:43], s51 offen offset:0 sc1
    buffer_load_dwordx4 v[40:43], v2, s[40:43], s51 offen offset:1024 sc1
    buffer_load_dwordx4 v[44:47], v3, s[40:43], s51 offen offset:1024 sc1
    buffer_load_dwordx2 v[50:51], v4, s[40:43], s51 offen offset:2048 sc1
    buffer_load_dwordx2 v[54:55], v5, s[40:43], s51 offen offset:2048 sc1
    s_add_u32 s67, s67, 1
    s_waitcnt vmcnt(0)
    v_add3_u32 v8, v32, v33, v34
    v_add3_u32 v9, v35, v36, v37
    v_add3_u32 v8, v8, v38, v39
    v_add3_u32 v9, v9, v40, v41
    v_add3_u32 v8, v8, v42, v43
    v_add3_u32 v9, v9, v44, v45
    v_add3_u32 v8, v8, v46, v47
    v_add3_u32 v9, v9, v50, v51
    v_add3_u32 v8, v8, v54, v55
    v_add_u32 v8, v8, v9
    s_nop 1
    v_add_u32_dpp v8, v8, v8 row_shr:1 row_mask:0xf bank_mask:0xf bound_ctrl:0
    s_nop 1
    v_add_u32_dpp v8, v8, v8 row_shr:2 row_mask:0xf bank_mask:0xf bound_ctrl:0
    s_nop 1
    v_add_u32_dpp v8, v8, v8 row_shr:4 row_mask:0xf bank_mask:0xf bound_ctrl:0
    s_nop 1
    v_add_u32_dpp v8, v8, v8 row_shr:8 row_mask:0xf bank_mask:0xf bound_ctrl:0
    s_nop 1
    v_add_u32_dpp v8, v8, v8 row_bcast:15 row_mask:0xa bank_mask:0xf
    s_nop 1
    v_add_u32_dpp v8, v8, v8 row_bcast:31 row_mask:0xc bank_mask:0xf
    s_nop 0
    v_readlane_b32 s66, v8, 63
    s_add_u32 s3, s27, s35
    s_cmp_lg_u32 s66, s3
    s_cselect_b32 s66, 1, 0
    s_xor_b32 s3, s24, s11
    s_or_b32 s66, s66, s3
    s_xor_b32 s3, s26, s11
    s_or_b32 s66, s66, s3
    s_xor_b32 s3, s28, s11
    s_or_b32 s66, s66, s3
    s_xor_b32 s3, s30, s11
    s_or_b32 s66, s66, s3
    s_xor_b32 s3, s32, s11
    s_or_b32 s66, s66, s3
    s_xor_b32 s3, s34, s11
    s_or_b32 s66, s66, s3
    s_xor_b32 s3, s36, s11
    s_or_b32 s66, s66, s3
    s_xor_b32 s3, s38, s11
    s_or_b32 s66, s66, s3
    s_cbranch_scc0 L_rt1
    s_cmp_lt_u32 s67, 0x40000
    s_cbranch_scc1 L_sm1
    s_branch L_rt1
L_sl2:
    s_mov_b32 s67, 0
L_sm2:
    s_load_dwordx16 s[24:39], s[22:23], s49 glc
    s_waitcnt lgkmcnt(0)
    buffer_load_dwordx4 v[56:59], v2, s[40:43], s52 offen offset:0 sc1
    buffer_load_dwordx4 v[60:63], v3, s[40:43], s52 offen offset:0 sc1
    buffer_load_dwordx4 v[64:67], v2, s[40:43], s52 offen offset:1024 sc1
    buffer_load_dwordx4 v[68:71], v3, s[40:43], s52 offen offset:1024 sc1
    buffer_load_dwordx2 v[88:89], v4, s[40:43], s52 offen offset:2048 sc1
    buffer_load_dwordx2 v[92:93], v5, s[40:43], s52 offen offset:2048 sc1
    s_add_u32 s67, s67, 1
    s_waitcnt vmcnt(0)
    v_add3_u32 v8, v56, v57, v58
    v_add3_u32 v9, v59, v60, v61
    v_add3_u32 v8, v8, v62, v63
    v_add3_u32 v9, v9, v64, v65
    v_add3_u32 v8, v8, v66, v67
    v_add3_u32 v9, v9, v68, v69
    v_add3_u32 v8, v8, v70, v71
    v_add3_u32 v9, v9, v88, v89
    v_add3_u32 v8, v8, v92, v93
    v_add_u32 v8, v8, v9
    s_nop 1
    v_add_u32_dpp v8, v8, v8 row_shr:1 row_mask:0xf bank_mask:0xf bound_ctrl:0
    s_nop 1
    v_add_u32_dpp v8, v8, v8 row_shr:2 row_mask:0xf bank_mask:0xf bound_ctrl:0
    s_nop 1
    v_add_u32_dpp v8, v8, v8 row_shr:4 row_mask:0xf bank_mask:0xf bound_ctrl:0
    s_nop 1
    v_add_u32_dpp v8, v8, v8 row_shr:8 row_mask:0xf bank_mask:0xf bound_ctrl:0
    s_nop 1
    v_add_u32_dpp v8, v8, v8 row_bcast:15 row_mask:0xa bank_mask:0xf
    s_nop 1
    v_add_u32_dpp v8, v8, v8 row_bcast:31 row_mask:0xc bank_mask:0xf
    s_nop 0
    v_readlane_b32 s66, v8, 63
    s_add_u32 s3, s29, s37
    s_cmp_lg_u32 s66, s3
    s_cselect_b32 s66, 1, 0
    s_xor_b32 s3, s24, s11
    s_or_b32 s66, s66, s3
    s_xor_b32 s3, s26, s11
    s_or_b32 s66, s66, s3
    s_xor_b32 s3, s28, s11
    s_or_b32 s66, s66, s3
    s_xor_b32 s3, s30, s11
    s_or_b32 s66, s66, s3
    s_xor_b32 s3, s32, s11
    s_or_b32 s66, s66, s3
    s_xor_b32 s3, s34, s11
    s_or_b32 s66, s66, s3
    s_xor_b32 s3, s36, s11
    s_or_b32 s66, s66, s3
    s_xor_b32 s3, s38, s11
    s_or_b32 s66, s66, s3
    s_cbranch_scc0 L_rt2
    s_cmp_lt_u32 s67, 0x40000
    s_cbranch_scc1 L_sm2
    s_branch L_rt2
L_sl3:
    s_mov_b32 s67, 0
L_sm3:
    s_load_dwordx16 s[24:39], s[22:23], s49 glc
    s_waitcnt lgkmcnt(0)
    buffer_load_dwordx4 v[72:75], v2, s[40:43], s53 offen offset:0 sc1
    buffer_load_dwordx4 v[76:79], v3, s[40:43], s53 offen offset:0 sc1
    buffer_load_dwordx4 v[80:83], v2, s[40:43], s53 offen offset:1024 sc1
    buffer_load_dwordx4 v[84:87], v3, s[40:43], s53 offen offset:1024 sc1
    buffer_load_dwordx2 v[90:91], v4, s[40:43], s53 offen offset:2048 sc1
    buffer_load_dwordx2 v[94:95], v5, s[40:43], s53 offen offset:2048 sc1
    s_add_u32 s67, s67, 1
    s_waitcnt vmcnt(0)
    v_add3_u32 v8, v72, v73, v74
    v_add3_u32 v9, v75, v76, v77
    v_add3_u32 v8, v8, v78, v79
    v_add3_u32 v9, v9, v80, v81
    v_add3_u32 v8, v8, v82, v83
    v_add3_u32 v9, v9, v84, v85
    v_add3_u32 v8, v8, v86, v87
    v_add3_u32 v9, v9, v90, v91
    v_add3_u32 v8, v8, v94, v95
    v_add_u32 v8, v8, v9
    s_nop 1
    v_add_u32_dpp v8, v8, v8 row_shr:1 row_mask:0xf bank_mask:0xf bound_ctrl:0
    s_nop 1
    v_add_u32_dpp v8, v8, v8 row_shr:2 row_mask:0xf bank_mask:0xf bound_ctrl:0
    s_nop 1
    v_add_u32_dpp v8, v8, v8 row_shr:4 row_mask:0xf bank_mask:0xf bound_ctrl:0
    s_nop 1
    v_add_u32_dpp v8, v8, v8 row_shr:8 row_mask:0xf bank_mask:0xf bound_ctrl:0
    s_nop 1
    v_add_u32_dpp v8, v8, v8 row_bcast:15 row_mask:0xa bank_mask:0xf
    s_nop 1
    v_add_u32_dpp v8, v8, v8 row_bcast:31 row_mask:0xc bank_mask:0xf
    s_nop 0
    v_readlane_b32 s66, v8, 63
    s_add_u32 s3, s31, s39
    s_cmp_lg_u32 s66, s3
    s_cselect_b32 s66, 1, 0
    s_xor_b32 s3, s24, s11
    s_or_b32 s66, s66, s3
    s_xor_b32 s3, s26, s11
    s_or_b32 s66, s66, s3
    s_xor_b32 s3, s28, s11
    s_or_b32 s66, s66, s3
    s_xor_b32 s3, s30, s11
    s_or_b32 s66, s66, s3
    s_xor_b32 s3, s32, s11
    s_or_b32 s66, s66, s3
    s_xor_b32 s3, s34, s11
    s_or_b32 s66, s66, s3
    s_xor_b32 s3, s36, s11
    s_or_b32 s66, s66, s3
    s_xor_b32 s3, s38, s11
    s_or_b32 s66, s66, s3
    s_cbranch_scc0 L_rt3
    s_cmp_lt_u32 s67, 0x40000
    s_cbranch_scc1 L_sm3
    s_branch L_rt3
L_end:
    s_endpgm
.section .rodata,"a"
.p2align 6
.amdhsa_kernel gated_mix__sliding_local_dilated__sliding_local_dilated__prompt_kernel
  .amdhsa_next_free_vgpr 256
  .amdhsa_next_free_sgpr 102
  .amdhsa_accum_offset 152
  .amdhsa_group_segment_fixed_size 0
  .amdhsa_kernarg_size 80
  .amdhsa_user_sgpr_count 2
  .amdhsa_user_sgpr_kernarg_segment_ptr 1
  .amdhsa_system_sgpr_workgroup_id_x 1
  .amdhsa_float_denorm_mode_32 3
  .amdhsa_float_denorm_mode_16_64 3
.end_amdhsa_kernel
```
